```python
import torch

def _softmax(x, axis=-1):
    return torch.softmax(x, dim=axis)
def _gelu(x):
    return torch.nn.functional.gelu(x, approximate="tanh")
def _silu(x):
    return torch.nn.functional.silu(x)
def _sigmoid(x):
    return torch.sigmoid(x)
def _layernorm(x, axis=-1, eps=1e-5):
    m = x.mean(dim=axis, keepdim=True)
    v = x.var(dim=axis, keepdim=True, unbiased=False)
    return (x - m) / torch.sqrt(v + eps)
def _scatter_add(tgt, idx, src, axis=0):
    return tgt.clone().index_add_(axis, idx, src)
def _segment_sum(src, seg, n):
    out = torch.zeros((n,) + src.shape[1:], dtype=src.dtype)
    return out.index_add_(0, seg, src)
def _pad(x, pw):
    flat = tuple(v for pair in reversed(pw) for v in pair)
    return torch.nn.functional.pad(x, flat)

kernel_name = 'concat_heads__ssm_conv_h3__sliding_block__prompt'

def setup_inputs():

    _w = (lambda a: (lambda t: t.to(torch.bfloat16) if t.is_floating_point() else t)(torch.as_tensor(a)))
    def _A_setup():
        B, S, D = 1, 2048, 512
        ks = 4
        return {
            "q": _w((lambda *s: torch.randn(*s, dtype=torch.bfloat16) * 0.05)(B, S, D)),
            "k": _w((lambda *s: torch.randn(*s, dtype=torch.bfloat16) * 0.8)(B, S, D)),
            "v": _w((lambda *s: torch.randn(*s, dtype=torch.bfloat16) * 0.8)(B, S, D)),
            "shift_k": _w((lambda *s: torch.randn(*s, dtype=torch.bfloat16) * 0.8)(D, ks) * 0.5),
            "ssm_k": _w((lambda *s: torch.randn(*s, dtype=torch.bfloat16) * 1.6)(D, S) * (1.0 / S ** 0.5)),
            "ssm_D": _w((lambda *s: torch.randn(*s, dtype=torch.bfloat16) * 0.8)(D)),
        }
    _A_in = _A_setup()

    def _B_setup():
        B, S, D = 1, 2048, 512
        return {
            "x": _w((lambda *s: torch.randn(*s, dtype=torch.bfloat16) * 0.2)(B, S, D)),
            "wqkv": _w((lambda *s: torch.randn(*s, dtype=torch.bfloat16) * 0.2)(D, 3 * D)),
            "wo": _w((lambda *s: torch.randn(*s, dtype=torch.bfloat16) * 0.05)(D, D)),
        }
    _B_in = _B_setup()

    return {
        "A_q": _A_in["q"],
        "A_k": _A_in["k"],
        "A_v": _A_in["v"],
        "A_shift_k": _A_in["shift_k"],
        "A_ssm_k": _A_in["ssm_k"],
        "A_ssm_D": _A_in["ssm_D"],
        "B_x": _B_in["x"],
        "B_wqkv": _B_in["wqkv"],
        "B_wo": _B_in["wo"],
    }

def reference(A_q, A_k, A_v, A_shift_k, A_ssm_k, A_ssm_D, B_x, B_wqkv, B_wo):
    def _A_ref(q, k, v, shift_k, ssm_k, ssm_D):
        B, S, D = q.shape
        ks = shift_k.shape[-1]
        k_pad = _pad(k, ((0, 0), (ks - 1, 0), (0, 0)))
        k_shift = torch.zeros_like(k)
        for t in range(ks):
            k_shift = k_shift + k_pad[:, t:t + S, :] * shift_k[:, ks - 1 - t][None, None, :]
        kv = k_shift * v
        L = 2 * S
        kv_pad = _pad(kv, ((0, 0), (0, S), (0, 0)))
        kf_pad = _pad(ssm_k, ((0, 0), (0, S)))
        kv_f = (lambda x, axes=(-2,-1): torch.fft.rfft2(x.float(), dim=axes))(kv_pad[:, None, :, :], axes=(1, 2))
        kf_f = (lambda x, axes=(-2,-1): torch.fft.rfft2(x.float(), dim=axes))(kf_pad[:, None, :], axes=(1, 2))
        kf_f = (lambda x, *d: x.permute(*d))(kf_f, 1, 2, 0)
        y_f = kv_f * kf_f[None, :, :, :]
        y = (lambda x, s, axes=(-2,-1): torch.fft.irfft2(x, s=s, dim=axes).to(torch.bfloat16))(y_f, (1, L), axes=(1, 2))[:, 0, :S, :]
        y = y + kv * ssm_D[None, None, :]
        return q * y

    def _B_ref(x, wqkv, wo):
        B, S, D = x.shape
        H = 32; Dh = D // H; W = 256
        qkv = (lambda x, *d: x.permute(*d))((x @ wqkv).reshape(B, S, 3, H, Dh), 2, 0, 3, 1, 4)
        q, k, v = qkv[0], qkv[1], qkv[2]
        scores = torch.einsum("bhqd,bhkd->bhqk", q, k) * (Dh ** -0.5)
        idx = torch.arange(S)
        mask = (idx[:, None] - idx[None, :] >= 0) & (idx[:, None] - idx[None, :] < W)
        scores = torch.where(mask[None, None], scores, -1e9)
        p = _softmax(scores, axis=-1)
        o = torch.einsum("bhqk,bhkd->bhqd", p, v)
        return (lambda x, *d: x.permute(*d))(o, 0, 2, 1, 3).reshape(B, S, D) @ wo

    a = _A_ref(A_q, A_k, A_v, A_shift_k, A_ssm_k, A_ssm_D)
    b = _B_ref(B_x, B_wqkv, B_wo)
    return torch.concatenate([a, b], axis=-1)
```

```asm
; @launch grid=(512,1,1) block=(256,1,1) lds=81920
.amdgcn_target "amdgcn-amd-amdhsa--gfx950"
.text
.globl concat_heads__ssm_conv_h3__sliding_block__prompt_kernel
.p2align 8
.type concat_heads__ssm_conv_h3__sliding_block__prompt_kernel,@function
concat_heads__ssm_conv_h3__sliding_block__prompt_kernel:
    s_cmp_ge_u32 s2, 32
    s_cbranch_scc1 L_nopf
    s_getpc_b64 s[60:61]
L_pc:
    s_lshr_b32 s3, s2, 3
    v_and_b32 v1, 0xcf, v0
    v_lshl_add_u32 v1, s3, 4, v1
    v_lshlrev_b32 v1, 7, v1
    v_min_u32 v1, L_hot_end-L_pc-4, v1
    s_mov_b64 exec, 0xffff
    global_load_dword v110, v1, s[60:61]
    s_mov_b64 exec, -1
L_nopf:
    s_cmp_ge_u32 s2, 256
    s_cbranch_scc1 L_A
    s_load_dwordx2 s[4:5], s[0:1], 48
    s_load_dwordx2 s[8:9], s[0:1], 56
    v_lshrrev_b32 v1, 6, v0
    v_lshrrev_b32 v2, 3, v0
    s_and_b32 s24, s2, 7
    v_readfirstlane_b32 s28, v1
    s_lshr_b32 s30, s2, 6
    s_bfe_u32 s27, s2, 0x30003
    s_lshl2_add_u32 s26, s24, s30
    v_lshl_add_u32 v1, v1, 3, v2
    v_and_b32 v2, 7, v0
    v_bfe_u32 v3, v0, 4, 2
    v_xor_b32 v4, v2, v3
    s_lshl_b32 s31, s26, 16
    v_lshlrev_b32 v4, 4, v4
    v_lshl_add_u32 v4, v1, 10, v4
    v_add_u32 v208, s31, v4
    v_and_b32 v3, 1, v3
    v_xor_b32 v4, 64, v208
    v_lshlrev_b32 v3, 2, v3
    v_add_u32 v209, 7168, v4
    v_xor_b32 v3, v3, v2
    s_lshl_b32 s32, s27, 7
    v_lshl_add_u32 v3, v3, 4, s32
    s_movk_i32 s33, 3072
    v_mad_u32_u24 v212, v1, s33, v3
    s_add_u32 s29, s24, s27
    v_add_u32 v210, 1024, v212
    s_lshl_b32 s29, s29, 7
    v_add_u32 v211, 23552, v212
    s_lshl_b32 s35, s28, 11
    s_lshl_b32 s36, s28, 12
    s_mov_b32 s6, 2097152
    s_mov_b32 s7, 0x20000
    s_mov_b32 s10, 1572864
    s_mov_b32 s11, 0x20000
    s_waitcnt lgkmcnt(0)
    s_and_b32 s29, s29, 0x380
    s_add_u32 m0, s35, 0
    s_mul_i32 s34, s29, 1536
    buffer_load_dwordx4 v208, s[4:7], s29 offen lds
    buffer_load_dwordx4 v209, s[4:7], s29 offen offset:1024 lds
    s_add_u32 m0, s36, 8192
    s_addk_i32 s29, 128
    buffer_load_dwordx4 v210, s[8:11], s34 offen lds
    buffer_load_dwordx4 v210, s[8:11], s34 offen offset:1024 lds
    buffer_load_dwordx4 v211, s[8:11], s34 offen offset:2048 lds
    buffer_load_dwordx4 v211, s[8:11], s34 offen offset:3072 lds
    s_and_b32 s29, s29, 0x380
    s_add_u32 m0, s35, 24576
    s_mul_i32 s34, s29, 1536
    buffer_load_dwordx4 v208, s[4:7], s29 offen lds
    buffer_load_dwordx4 v209, s[4:7], s29 offen offset:1024 lds
    s_add_u32 m0, s36, 32768
    s_addk_i32 s29, 128
    buffer_load_dwordx4 v210, s[8:11], s34 offen lds
    buffer_load_dwordx4 v210, s[8:11], s34 offen offset:1024 lds
    buffer_load_dwordx4 v211, s[8:11], s34 offen offset:2048 lds
    buffer_load_dwordx4 v211, s[8:11], s34 offen offset:3072 lds
    s_branch L_B2
L_A:
    s_cmp_ge_u32 s2, 512
    s_cbranch_scc1 L_end
    s_setprio 3
    s_load_dwordx2 s[4:5], s[0:1], 8
    s_load_dwordx2 s[8:9], s[0:1], 16
    s_load_dwordx2 s[16:17], s[0:1], 32
    s_load_dwordx2 s[28:29], s[0:1], 24
    v_lshrrev_b32 v2, 6, v0
    s_and_b32 s32, s2, 7
    s_bfe_u32 s33, s2, 0x50003
    v_readfirstlane_b32 s34, v2
    v_lshrrev_b32 v3, 3, v0
    v_and_b32 v4, 7, v0
    v_xor_b32 v5, v4, v2
    v_lshlrev_b32 v5, 4, v5
    s_lshl_b32 s35, s33, 16
    s_lshl_b32 s36, s32, 7
    s_add_u32 s35, s35, s36
    v_lshl_add_u32 v96, v3, 10, v5
    v_add_u32 v96, s35, v96
    v_xor_b32 v97, 64, v96
    v_add_u32 v97, 32768, v97
    v_subrev_u32 v18, 8192, v96
    v_subrev_u32 v19, 8192, v97
    s_lshl_b32 s48, s34, 10
    s_lshl_b32 s37, s32, 5
    s_add_u32 s37, s37, s33
    s_lshl_b32 s37, s37, 13
    v_lshl_add_u32 v25, v0, 4, s37
    v_subrev_u32 v26, 8, v25
    s_lshl_b32 s35, s32, 9
    v_lshl_add_u32 v6, v3, 4, s35
    s_mov_b32 s6, 2097152
    s_mov_b32 s7, 0x20000
    s_mov_b32 s10, 2097152
    s_mov_b32 s11, 0x20000
    s_mov_b32 s18, 2097152
    s_mov_b32 s19, 0x20000
    s_cmp_lg_u32 s34, 0
    s_waitcnt lgkmcnt(0)
    global_load_dwordx4 v[20:23], v6, s[28:29]
    s_cbranch_scc1 L_a_nok8
    s_mov_b32 m0, 8192
    s_mov_b32 s38, 57344
    buffer_load_dwordx4 v96, s[4:7], s38 offen lds
L_a_nok8:
    s_add_u32 m0, s48, 0
    s_nop 0
    buffer_load_dwordx4 v18, s[4:7], 0 offen lds
    s_add_u32 m0, s48, 4096
    s_nop 0
    buffer_load_dwordx4 v19, s[4:7], 0 offen lds
    s_add_u32 m0, s48, 9216
    s_nop 0
    buffer_load_dwordx4 v96, s[8:11], 0 offen lds
    s_add_u32 m0, s48, 13312
    s_nop 0
    buffer_load_dwordx4 v97, s[8:11], 0 offen lds
    s_movk_i32 s38, 4096
    buffer_load_dwordx4 v[30:33], v25, s[16:19], 0 offen
    buffer_load_dwordx4 v[38:41], v25, s[16:19], s38 offen
    buffer_load_dwordx2 v[28:29], v26, s[16:19], 0 offen
    buffer_load_dwordx2 v[36:37], v25, s[16:19], 0 offen offset:4088
    s_branch L_A1
L_B2:
    s_load_dwordx2 s[20:21], s[0:1], 88
    s_load_dwordx2 s[12:13], s[0:1], 64
    s_load_dwordx2 s[16:17], s[0:1], 72
    v_and_b32 v241, 63, v0
    s_lshr_b32 s25, s2, 3
    s_setprio 2
    v_and_b32 v7, 3, v0
    v_bfe_u32 v6, v0, 2, 2
    v_mul_u32_u24 v5, 3072, v7
    s_lshl2_add_u32 s31, s25, s28
    v_lshl_add_u32 v5, v6, 10, v5
    s_mul_i32 s32, s31, 12288
    s_add_u32 s32, s32, 384
    v_add_u32 v5, s32, v5
    s_mov_b64 exec, 0xfff
    buffer_load_dword v100, v5, s[8:11], 0 offen
    s_mov_b64 exec, -1
    s_mov_b32 s14, 524288
    s_mov_b32 s15, 0x20000
    s_mov_b32 s18, 4194304
    s_mov_b32 s19, 0x20000
    s_mov_b32 s22, 16777216
    s_mov_b32 s23, 0x20000
    s_xor_b32 s63, s27, 4
    v_xor_b32 v3, 512, v3
    v_bfe_u32 v5, v0, 3, 3
    v_lshl_add_u32 v244, v5, 10, v3
    v_add_u32 v245, 7168, v244
    v_add_u32 v246, 14336, v244
    v_add_u32 v247, 21504, v244
    v_lshlrev_b32 v240, 4, v241
    s_and_b32 s30, s28, 1
    s_lshr_b32 s31, s28, 1
    v_and_b32 v1, 31, v0
    v_bfe_u32 v2, v0, 5, 1
    v_bfe_u32 v3, v0, 1, 3
    s_lshl_b32 s32, s30, 12
    v_lshl_add_u32 v1, v1, 7, s32
    v_add_u32 v4, 0, v2
    v_xor_b32 v4, v4, v3
    v_lshl_add_u32 v216, v4, 4, v1
    v_add_u32 v4, 2, v2
    v_xor_b32 v4, v4, v3
    v_lshl_add_u32 v217, v4, 4, v1
    v_add_u32 v4, 4, v2
    v_xor_b32 v4, v4, v3
    v_lshl_add_u32 v218, v4, 4, v1
    v_add_u32 v4, 6, v2
    v_xor_b32 v4, v4, v3
    v_lshl_add_u32 v219, v4, 4, v1
    v_bfe_u32 v4, v0, 2, 2
    v_bfe_u32 v5, v0, 3, 1
    v_xor_b32 v5, s31, v5
    v_lshlrev_b32 v5, 6, v5
    v_lshl_add_u32 v5, v4, 7, v5
    v_bfe_u32 v6, v0, 4, 1
    v_lshl_add_u32 v5, v6, 5, v5
    v_and_b32 v7, 3, v0
    v_lshl_add_u32 v5, v7, 3, v5
    v_lshl_add_u32 v213, v2, 11, v5
    v_lshl_add_u32 v214, v2, 10, v5
    v_add_u32 v213, 8192, v213
    v_add_u32 v215, 49152, v214
    v_and_b32 v8, 15, v0
    v_lshlrev_b32 v8, 4, v8
    v_lshl_add_u32 v242, v2, 8, v8
    v_lshl_add_u32 v220, v6, 17, v242
    s_lshl_b32 s32, s31, 12
    s_lshl_b32 s33, s30, 10
    s_add_u32 s32, s32, s33
    v_lshl_add_u32 v222, v6, 11, v242
    v_add_u32 v222, s32, v222
    s_add_u32 s32, s32, 57344
    v_add_u32 v221, s32, v240
    s_lshl1_add_u32 s32, s27, s31
    s_lshl_b32 s32, s32, 18
    s_lshl1_add_u32 s33, s26, s30
    s_lshl_b32 s33, s33, 11
    s_add_u32 s32, s32, s33
    s_add_u32 s58, s32, 65536
    s_add_u32 s59, s32, 196608
    s_lshl2_add_u32 s30, s27, s28
    s_lshl3_add_u32 s45, s26, s28
    s_lshl_b32 s45, s45, 14
    s_lshl_b32 s31, s63, 7
    s_add_u32 s45, s45, s31
    s_add_u32 s45, s45, 1024
    s_lshl_b32 s51, s30, 17
    s_lshl_b32 s31, s26, 12
    s_add_u32 s51, s51, s31
    s_add_u32 s51, s51, 61440
    s_lshl_b32 s54, s26, 7
    s_add_u32 s54, s54, 7352320
    s_lshl2_add_u32 s50, s30, s54
    v_and_b32 v1, 31, v0
    v_lshl_add_u32 v249, v1, 2, s54
    s_lshl3_add_u32 s31, s26, s27
    s_lshl_b32 s31, s31, 7
    s_add_u32 s31, s31, 7372800
    v_lshl_add_u32 v248, v7, 2, s31
    s_mul_i32 s32, s28, 1028
    s_add_u32 s32, s32, s31
    s_add_u32 s32, s32, 1024
    v_mov_b32 v223, s32
    s_lshl_b32 s52, s28, 14
    s_lshl_b32 s53, s28, 17
    s_min_u32 s44, s26, 4
    s_getreg_b32 s46, hwreg(HW_REG_XCC_ID, 0, 4)
    s_mov_b32 s47, 96
    s_mov_b32 s56, 0x3f803f80
    s_mov_b32 s57, 0x3f803f80
    s_mov_b32 s48, 0xffff
    s_mov_b32 s49, 0xffff
    s_lshl2_add_u32 s30, s26, 7340160
    s_lshl2_add_u32 s31, s28, s30
    s_waitcnt lgkmcnt(0)
    s_load_dword s41, s[20:21], s30
    s_load_dword s42, s[20:21], s31 offset:4
    buffer_load_dword v102, v249, s[20:23], 0 offen sc1
    s_mov_b32 s32, 69632
    buffer_load_dword v108, v249, s[20:23], s32 offen sc1
    buffer_load_dword v106, v248, s[20:23], 0 offen sc1
    v_and_b32 v255, 31, v241
    v_lshrrev_b32 v253, 5, v241
    v_lshlrev_b32 v253, 2, v253
    v_sub_u32 v255, v255, v253
    v_mov_b32 v253, 0xf149f2ca
    v_cmp_gt_i32 vcc, 0, v255
    v_cmp_gt_i32 s[38:39], 1, v255
    s_nop 0
    v_cndmask_b32 v224, 0, v253, vcc
    v_cndmask_b32 v225, 0, v253, s[38:39]
    v_cmp_gt_i32 vcc, 2, v255
    v_cmp_gt_i32 s[38:39], 3, v255
    s_nop 0
    v_cndmask_b32 v226, 0, v253, vcc
    v_cndmask_b32 v227, 0, v253, s[38:39]
    v_cmp_gt_i32 vcc, 8, v255
    v_cmp_gt_i32 s[38:39], 9, v255
    s_nop 0
    v_cndmask_b32 v228, 0, v253, vcc
    v_cndmask_b32 v229, 0, v253, s[38:39]
    v_cmp_gt_i32 vcc, 10, v255
    v_cmp_gt_i32 s[38:39], 11, v255
    s_nop 0
    v_cndmask_b32 v230, 0, v253, vcc
    v_cndmask_b32 v231, 0, v253, s[38:39]
    v_cmp_gt_i32 vcc, 16, v255
    v_cmp_gt_i32 s[38:39], 17, v255
    s_nop 0
    v_cndmask_b32 v232, 0, v253, vcc
    v_cndmask_b32 v233, 0, v253, s[38:39]
    v_cmp_gt_i32 vcc, 18, v255
    v_cmp_gt_i32 s[38:39], 19, v255
    s_nop 0
    v_cndmask_b32 v234, 0, v253, vcc
    v_cndmask_b32 v235, 0, v253, s[38:39]
    v_cmp_gt_i32 vcc, 24, v255
    v_cmp_gt_i32 s[38:39], 25, v255
    s_nop 0
    v_cndmask_b32 v236, 0, v253, vcc
    v_cndmask_b32 v237, 0, v253, s[38:39]
    v_cmp_gt_i32 vcc, 26, v255
    v_cmp_gt_i32 s[38:39], 27, v255
    s_nop 0
    v_cndmask_b32 v238, 0, v253, vcc
    v_cndmask_b32 v239, 0, v253, s[38:39]
    v_subrev_u32 v255, 8192, v221
    v_add_u32 v252, s35, v240
    v_add_u32 v251, s35, v242
    v_add_u32 v250, 57344, v252
    s_lshl_b32 s38, 1, s44
    s_sub_u32 s38, s38, 1
    s_mov_b32 s39, 0
    s_mov_b32 s31, 0x3eb8aa3b
    s_add_u32 s33, s45, 65536
    s_waitcnt vmcnt(10)
    s_barrier
    ds_read_b128 v[0:3], v216 offset:0
    ds_read_b64_tr_b16 v[128:129], v213 offset:0
    ds_read_b64_tr_b16 v[130:131], v213 offset:512
    ds_read_b64_tr_b16 v[132:133], v213 offset:1024
    ds_read_b64_tr_b16 v[134:135], v213 offset:1536
    s_and_b32 s29, s29, 0x380
    s_add_u32 m0, s35, 49152
    s_mul_i32 s34, s29, 1536
    buffer_load_dwordx4 v208, s[4:7], s29 offen lds
    ds_read_b128 v[4:7], v217 offset:0
    ds_read_b64_tr_b16 v[136:137], v213 offset:4096
    ds_read_b64_tr_b16 v[138:139], v213 offset:4608
    ds_read_b64_tr_b16 v[140:141], v213 offset:5120
    ds_read_b64_tr_b16 v[142:143], v213 offset:5632
    buffer_load_dwordx4 v209, s[4:7], s29 offen offset:1024 lds
    ds_read_b128 v[8:11], v218 offset:0
    ds_read_b64_tr_b16 v[144:145], v213 offset:8192
    ds_read_b64_tr_b16 v[146:147], v213 offset:8704
    s_add_u32 m0, s36, 57344
    s_addk_i32 s29, 128
    buffer_load_dwordx4 v210, s[8:11], s34 offen lds
    s_waitcnt lgkmcnt(8)
    v_mfma_f32_32x32x16_bf16 v[160:175], v[128:131], v[0:3], 0
    ds_read_b64_tr_b16 v[148:149], v213 offset:9216
    ds_read_b64_tr_b16 v[150:151], v213 offset:9728
    buffer_load_dwordx4 v210, s[8:11], s34 offen offset:1024 lds
    v_mfma_f32_32x32x16_bf16 v[176:191], v[0:3], v[132:135], 0
    ds_read_b128 v[12:15], v219 offset:0
    ds_read_b64_tr_b16 v[152:153], v213 offset:12288
    ds_read_b64_tr_b16 v[154:155], v213 offset:12800
    s_waitcnt lgkmcnt(8)
    v_mfma_f32_32x32x16_bf16 v[160:175], v[136:139], v[4:7], v[160:175]
    ds_read_b64_tr_b16 v[156:157], v213 offset:13312
    ds_read_b64_tr_b16 v[158:159], v213 offset:13824
    buffer_load_dwordx4 v211, s[8:11], s34 offen offset:2048 lds
    v_mfma_f32_32x32x16_bf16 v[176:191], v[4:7], v[140:143], v[176:191]
    buffer_load_dwordx4 v211, s[8:11], s34 offen offset:3072 lds
    s_waitcnt lgkmcnt(0)
    s_waitcnt vmcnt(10)
    s_barrier
    s_add_u32 s43, s41, 0x9e377900
    s_add_u32 s42, s42, 0x9e377900
    s_and_b32 s43, s43, 0xffffff00
    s_and_b32 s42, s42, 0xffffff00
    s_or_b32 s46, s46, s43
    v_mov_b32 v243, s42
    ds_read_b128 v[16:19], v216 offset:24576
    ds_read_b64_tr_b16 v[128:129], v213 offset:24576
    ds_read_b64_tr_b16 v[130:131], v213 offset:25088
    v_mfma_f32_32x32x16_bf16 v[160:175], v[144:147], v[8:11], v[160:175]
    ds_read_b64_tr_b16 v[132:133], v213 offset:25600
    ds_read_b64_tr_b16 v[134:135], v213 offset:26112
    s_and_b32 s29, s29, 0x380
    s_add_u32 m0, s35, 0
    s_mul_i32 s34, s29, 1536
    buffer_load_dwordx4 v208, s[4:7], s29 offen lds
    v_mfma_f32_32x32x16_bf16 v[176:191], v[8:11], v[148:151], v[176:191]
    ds_read_b128 v[20:23], v217 offset:24576
    ds_read_b64_tr_b16 v[136:137], v213 offset:28672
    ds_read_b64_tr_b16 v[138:139], v213 offset:29184
    v_mfma_f32_32x32x16_bf16 v[160:175], v[152:155], v[12:15], v[160:175]
    ds_read_b64_tr_b16 v[140:141], v213 offset:29696
    ds_read_b64_tr_b16 v[142:143], v213 offset:30208
    buffer_load_dwordx4 v209, s[4:7], s29 offen offset:1024 lds
    v_mfma_f32_32x32x16_bf16 v[176:191], v[12:15], v[156:159], v[176:191]
    ds_read_b128 v[24:27], v218 offset:24576
    ds_read_b64_tr_b16 v[144:145], v213 offset:32768
    ds_read_b64_tr_b16 v[146:147], v213 offset:33280
    s_add_u32 m0, s36, 8192
    s_addk_i32 s29, 128
    buffer_load_dwordx4 v210, s[8:11], s34 offen lds
    s_waitcnt lgkmcnt(8)
    v_mfma_f32_32x32x16_bf16 v[160:175], v[128:131], v[16:19], v[160:175]
    ds_read_b64_tr_b16 v[148:149], v213 offset:33792
    ds_read_b64_tr_b16 v[150:151], v213 offset:34304
    buffer_load_dwordx4 v210, s[8:11], s34 offen offset:1024 lds
    v_mfma_f32_32x32x16_bf16 v[176:191], v[16:19], v[132:135], v[176:191]
    ds_read_b128 v[28:31], v219 offset:24576
    ds_read_b64_tr_b16 v[152:153], v213 offset:36864
    ds_read_b64_tr_b16 v[154:155], v213 offset:37376
    s_waitcnt lgkmcnt(8)
    v_mfma_f32_32x32x16_bf16 v[160:175], v[136:139], v[20:23], v[160:175]
    ds_read_b64_tr_b16 v[156:157], v213 offset:37888
    ds_read_b64_tr_b16 v[158:159], v213 offset:38400
    buffer_load_dwordx4 v211, s[8:11], s34 offen offset:2048 lds
    v_mfma_f32_32x32x16_bf16 v[176:191], v[20:23], v[140:143], v[176:191]
    buffer_load_dwordx4 v211, s[8:11], s34 offen offset:3072 lds
    s_waitcnt lgkmcnt(0)
    s_waitcnt vmcnt(6)
    s_barrier
    ds_read_b128 v[32:35], v216 offset:49152
    ds_read_b64_tr_b16 v[128:129], v213 offset:49152
    ds_read_b64_tr_b16 v[130:131], v213 offset:49664
    v_mfma_f32_32x32x16_bf16 v[160:175], v[144:147], v[24:27], v[160:175]
    ds_read_b64_tr_b16 v[132:133], v213 offset:50176
    ds_read_b64_tr_b16 v[134:135], v213 offset:50688
    s_and_b32 s29, s29, 0x380
    s_add_u32 m0, s35, 24576
    s_mul_i32 s34, s29, 1536
    buffer_load_dwordx4 v208, s[4:7], s29 offen lds
    v_mfma_f32_32x32x16_bf16 v[176:191], v[24:27], v[148:151], v[176:191]
    ds_read_b128 v[36:39], v217 offset:49152
    ds_read_b64_tr_b16 v[136:137], v213 offset:53248
    ds_read_b64_tr_b16 v[138:139], v213 offset:53760
    v_mfma_f32_32x32x16_bf16 v[160:175], v[152:155], v[28:31], v[160:175]
    ds_read_b64_tr_b16 v[140:141], v213 offset:54272
    ds_read_b64_tr_b16 v[142:143], v213 offset:54784
    buffer_load_dwordx4 v209, s[4:7], s29 offen offset:1024 lds
    v_mfma_f32_32x32x16_bf16 v[176:191], v[28:31], v[156:159], v[176:191]
    ds_read_b128 v[40:43], v218 offset:49152
    ds_read_b64_tr_b16 v[144:145], v213 offset:57344
    ds_read_b64_tr_b16 v[146:147], v213 offset:57856
    s_add_u32 m0, s36, 32768
    s_addk_i32 s29, 128
    buffer_load_dwordx4 v210, s[8:11], s34 offen lds
    s_waitcnt lgkmcnt(8)
    v_mfma_f32_32x32x16_bf16 v[160:175], v[128:131], v[32:35], v[160:175]
    ds_read_b64_tr_b16 v[148:149], v213 offset:58368
    ds_read_b64_tr_b16 v[150:151], v213 offset:58880
    buffer_load_dwordx4 v210, s[8:11], s34 offen offset:1024 lds
    v_mfma_f32_32x32x16_bf16 v[176:191], v[32:35], v[132:135], v[176:191]
    ds_read_b128 v[44:47], v219 offset:49152
    ds_read_b64_tr_b16 v[152:153], v213 offset:61440
    ds_read_b64_tr_b16 v[154:155], v213 offset:61952
    s_waitcnt lgkmcnt(8)
    v_mfma_f32_32x32x16_bf16 v[160:175], v[136:139], v[36:39], v[160:175]
    ds_read_b64_tr_b16 v[156:157], v213 offset:62464
    ds_read_b64_tr_b16 v[158:159], v213 offset:62976
    buffer_load_dwordx4 v211, s[8:11], s34 offen offset:2048 lds
    v_mfma_f32_32x32x16_bf16 v[176:191], v[36:39], v[140:143], v[176:191]
    buffer_load_dwordx4 v211, s[8:11], s34 offen offset:3072 lds
    s_waitcnt lgkmcnt(0)
    s_waitcnt vmcnt(6)
    s_barrier
    ds_read_b128 v[48:51], v216 offset:0
    ds_read_b64_tr_b16 v[128:129], v213 offset:0
    ds_read_b64_tr_b16 v[130:131], v213 offset:512
    v_mfma_f32_32x32x16_bf16 v[160:175], v[144:147], v[40:43], v[160:175]
    ds_read_b64_tr_b16 v[132:133], v213 offset:1024
    ds_read_b64_tr_b16 v[134:135], v213 offset:1536
    s_and_b32 s29, s29, 0x380
    s_add_u32 m0, s35, 49152
    s_mul_i32 s34, s29, 1536
    buffer_load_dwordx4 v208, s[4:7], s29 offen lds
    v_mfma_f32_32x32x16_bf16 v[176:191], v[40:43], v[148:151], v[176:191]
    ds_read_b128 v[52:55], v217 offset:0
    ds_read_b64_tr_b16 v[136:137], v213 offset:4096
    ds_read_b64_tr_b16 v[138:139], v213 offset:4608
    v_mfma_f32_32x32x16_bf16 v[160:175], v[152:155], v[44:47], v[160:175]
    ds_read_b64_tr_b16 v[140:141], v213 offset:5120
    ds_read_b64_tr_b16 v[142:143], v213 offset:5632
    buffer_load_dwordx4 v209, s[4:7], s29 offen offset:1024 lds
    v_mfma_f32_32x32x16_bf16 v[176:191], v[44:47], v[156:159], v[176:191]
    ds_read_b128 v[56:59], v218 offset:0
    ds_read_b64_tr_b16 v[144:145], v213 offset:8192
    ds_read_b64_tr_b16 v[146:147], v213 offset:8704
    s_add_u32 m0, s36, 57344
    s_addk_i32 s29, 128
    buffer_load_dwordx4 v210, s[8:11], s34 offen lds
    s_waitcnt lgkmcnt(8)
    v_mfma_f32_32x32x16_bf16 v[160:175], v[128:131], v[48:51], v[160:175]
    ds_read_b64_tr_b16 v[148:149], v213 offset:9216
    ds_read_b64_tr_b16 v[150:151], v213 offset:9728
    buffer_load_dwordx4 v210, s[8:11], s34 offen offset:1024 lds
    v_mfma_f32_32x32x16_bf16 v[176:191], v[48:51], v[132:135], v[176:191]
    ds_read_b128 v[60:63], v219 offset:0
    ds_read_b64_tr_b16 v[152:153], v213 offset:12288
    ds_read_b64_tr_b16 v[154:155], v213 offset:12800
    s_waitcnt lgkmcnt(8)
    v_mfma_f32_32x32x16_bf16 v[160:175], v[136:139], v[52:55], v[160:175]
    ds_read_b64_tr_b16 v[156:157], v213 offset:13312
    ds_read_b64_tr_b16 v[158:159], v213 offset:13824
    buffer_load_dwordx4 v211, s[8:11], s34 offen offset:2048 lds
    v_mfma_f32_32x32x16_bf16 v[176:191], v[52:55], v[140:143], v[176:191]
    buffer_load_dwordx4 v211, s[8:11], s34 offen offset:3072 lds
    s_waitcnt lgkmcnt(0)
    s_waitcnt vmcnt(6)
    s_barrier
    ds_read_b128 v[64:67], v216 offset:24576
    ds_read_b64_tr_b16 v[128:129], v213 offset:24576
    ds_read_b64_tr_b16 v[130:131], v213 offset:25088
    v_mfma_f32_32x32x16_bf16 v[160:175], v[144:147], v[56:59], v[160:175]
    ds_read_b64_tr_b16 v[132:133], v213 offset:25600
    ds_read_b64_tr_b16 v[134:135], v213 offset:26112
    s_and_b32 s29, s29, 0x380
    s_add_u32 m0, s35, 0
    s_mul_i32 s34, s29, 1536
    buffer_load_dwordx4 v208, s[4:7], s29 offen lds
    v_mfma_f32_32x32x16_bf16 v[176:191], v[56:59], v[148:151], v[176:191]
    ds_read_b128 v[68:71], v217 offset:24576
    ds_read_b64_tr_b16 v[136:137], v213 offset:28672
    ds_read_b64_tr_b16 v[138:139], v213 offset:29184
    v_mfma_f32_32x32x16_bf16 v[160:175], v[152:155], v[60:63], v[160:175]
    ds_read_b64_tr_b16 v[140:141], v213 offset:29696
    ds_read_b64_tr_b16 v[142:143], v213 offset:30208
    buffer_load_dwordx4 v209, s[4:7], s29 offen offset:1024 lds
    v_mfma_f32_32x32x16_bf16 v[176:191], v[60:63], v[156:159], v[176:191]
    ds_read_b128 v[72:75], v218 offset:24576
    ds_read_b64_tr_b16 v[144:145], v213 offset:32768
    ds_read_b64_tr_b16 v[146:147], v213 offset:33280
    s_add_u32 m0, s36, 8192
    s_addk_i32 s29, 128
    buffer_load_dwordx4 v210, s[8:11], s34 offen lds
    s_waitcnt lgkmcnt(8)
    v_mfma_f32_32x32x16_bf16 v[160:175], v[128:131], v[64:67], v[160:175]
    ds_read_b64_tr_b16 v[148:149], v213 offset:33792
    ds_read_b64_tr_b16 v[150:151], v213 offset:34304
    buffer_load_dwordx4 v210, s[8:11], s34 offen offset:1024 lds
    v_mfma_f32_32x32x16_bf16 v[176:191], v[64:67], v[132:135], v[176:191]
    ds_read_b128 v[76:79], v219 offset:24576
    ds_read_b64_tr_b16 v[152:153], v213 offset:36864
    ds_read_b64_tr_b16 v[154:155], v213 offset:37376
    s_waitcnt lgkmcnt(8)
    v_mfma_f32_32x32x16_bf16 v[160:175], v[136:139], v[68:71], v[160:175]
    ds_read_b64_tr_b16 v[156:157], v213 offset:37888
    ds_read_b64_tr_b16 v[158:159], v213 offset:38400
    buffer_load_dwordx4 v211, s[8:11], s34 offen offset:2048 lds
    v_mfma_f32_32x32x16_bf16 v[176:191], v[68:71], v[140:143], v[176:191]
    buffer_load_dwordx4 v211, s[8:11], s34 offen offset:3072 lds
    s_waitcnt lgkmcnt(0)
    s_waitcnt vmcnt(6)
    s_barrier
    ds_read_b128 v[80:83], v216 offset:49152
    ds_read_b64_tr_b16 v[128:129], v213 offset:49152
    ds_read_b64_tr_b16 v[130:131], v213 offset:49664
    v_mfma_f32_32x32x16_bf16 v[160:175], v[144:147], v[72:75], v[160:175]
    ds_read_b64_tr_b16 v[132:133], v213 offset:50176
    ds_read_b64_tr_b16 v[134:135], v213 offset:50688
    s_and_b32 s29, s29, 0x380
    s_add_u32 m0, s35, 24576
    s_mul_i32 s34, s29, 1536
    buffer_load_dwordx4 v208, s[4:7], s29 offen lds
    v_mfma_f32_32x32x16_bf16 v[176:191], v[72:75], v[148:151], v[176:191]
    ds_read_b128 v[84:87], v217 offset:49152
    ds_read_b64_tr_b16 v[136:137], v213 offset:53248
    ds_read_b64_tr_b16 v[138:139], v213 offset:53760
    v_mfma_f32_32x32x16_bf16 v[160:175], v[152:155], v[76:79], v[160:175]
    ds_read_b64_tr_b16 v[140:141], v213 offset:54272
    ds_read_b64_tr_b16 v[142:143], v213 offset:54784
    buffer_load_dwordx4 v209, s[4:7], s29 offen offset:1024 lds
    v_mfma_f32_32x32x16_bf16 v[176:191], v[76:79], v[156:159], v[176:191]
    ds_read_b128 v[88:91], v218 offset:49152
    ds_read_b64_tr_b16 v[144:145], v213 offset:57344
    ds_read_b64_tr_b16 v[146:147], v213 offset:57856
    s_add_u32 m0, s36, 32768
    s_addk_i32 s29, 128
    buffer_load_dwordx4 v210, s[8:11], s34 offen lds
    s_waitcnt lgkmcnt(8)
    v_mfma_f32_32x32x16_bf16 v[160:175], v[128:131], v[80:83], v[160:175]
    ds_read_b64_tr_b16 v[148:149], v213 offset:58368
    ds_read_b64_tr_b16 v[150:151], v213 offset:58880
    buffer_load_dwordx4 v210, s[8:11], s34 offen offset:1024 lds
    v_mfma_f32_32x32x16_bf16 v[176:191], v[80:83], v[132:135], v[176:191]
    ds_read_b128 v[92:95], v219 offset:49152
    ds_read_b64_tr_b16 v[152:153], v213 offset:61440
    ds_read_b64_tr_b16 v[154:155], v213 offset:61952
    s_waitcnt lgkmcnt(8)
    v_mfma_f32_32x32x16_bf16 v[160:175], v[136:139], v[84:87], v[160:175]
    ds_read_b64_tr_b16 v[156:157], v213 offset:62464
    ds_read_b64_tr_b16 v[158:159], v213 offset:62976
    buffer_load_dwordx4 v211, s[8:11], s34 offen offset:2048 lds
    v_mfma_f32_32x32x16_bf16 v[176:191], v[84:87], v[140:143], v[176:191]
    buffer_load_dwordx4 v211, s[8:11], s34 offen offset:3072 lds
    s_waitcnt lgkmcnt(0)
    s_waitcnt vmcnt(6)
    s_barrier
    ds_read_b128 v[96:99], v216 offset:0
    ds_read_b64_tr_b16 v[128:129], v213 offset:0
    ds_read_b64_tr_b16 v[130:131], v213 offset:512
    v_mfma_f32_32x32x16_bf16 v[160:175], v[144:147], v[88:91], v[160:175]
    ds_read_b64_tr_b16 v[132:133], v213 offset:1024
    ds_read_b64_tr_b16 v[134:135], v213 offset:1536
    s_and_b32 s29, s29, 0x380
    s_add_u32 m0, s35, 49152
    s_mul_i32 s34, s29, 1536
    buffer_load_dwordx4 v212, s[8:11], s34 offen lds
    v_mfma_f32_32x32x16_bf16 v[176:191], v[88:91], v[148:151], v[176:191]
    ds_read_b128 v[100:103], v217 offset:0
    ds_read_b64_tr_b16 v[136:137], v213 offset:4096
    ds_read_b64_tr_b16 v[138:139], v213 offset:4608
    v_mfma_f32_32x32x16_bf16 v[160:175], v[152:155], v[92:95], v[160:175]
    ds_read_b64_tr_b16 v[140:141], v213 offset:5120
    ds_read_b64_tr_b16 v[142:143], v213 offset:5632
    s_addk_i32 s29, 128
    buffer_load_dwordx4 v211, s[8:11], s34 offen offset:1024 lds
    v_mfma_f32_32x32x16_bf16 v[176:191], v[92:95], v[156:159], v[176:191]
    ds_read_b128 v[104:107], v218 offset:0
    ds_read_b64_tr_b16 v[144:145], v213 offset:8192
    ds_read_b64_tr_b16 v[146:147], v213 offset:8704
    s_and_b32 s29, s29, 0x380
    s_add_u32 m0, s35, 57344
    s_mul_i32 s34, s29, 1536
    buffer_load_dwordx4 v212, s[8:11], s34 offen lds
    s_waitcnt lgkmcnt(8)
    v_mfma_f32_32x32x16_bf16 v[160:175], v[128:131], v[96:99], v[160:175]
    ds_read_b64_tr_b16 v[148:149], v213 offset:9216
    ds_read_b64_tr_b16 v[150:151], v213 offset:9728
    s_addk_i32 s29, 128
    buffer_load_dwordx4 v211, s[8:11], s34 offen offset:1024 lds
    v_mfma_f32_32x32x16_bf16 v[176:191], v[96:99], v[132:135], v[176:191]
    ds_read_b128 v[108:111], v219 offset:0
    ds_read_b64_tr_b16 v[152:153], v213 offset:12288
    ds_read_b64_tr_b16 v[154:155], v213 offset:12800
    s_waitcnt lgkmcnt(8)
    v_mfma_f32_32x32x16_bf16 v[160:175], v[136:139], v[100:103], v[160:175]
    ds_read_b64_tr_b16 v[156:157], v213 offset:13312
    ds_read_b64_tr_b16 v[158:159], v213 offset:13824
    s_and_b32 s29, s29, 0x380
    s_add_u32 m0, s35, 65536
    s_mul_i32 s34, s29, 1536
    buffer_load_dwordx4 v212, s[8:11], s34 offen lds
    v_mfma_f32_32x32x16_bf16 v[176:191], v[100:103], v[140:143], v[176:191]
    s_addk_i32 s29, 128
    buffer_load_dwordx4 v211, s[8:11], s34 offen offset:1024 lds
    s_waitcnt lgkmcnt(0)
    s_waitcnt vmcnt(6)
    s_barrier
    ds_read_b128 v[112:115], v216 offset:24576
    ds_read_b64_tr_b16 v[128:129], v213 offset:24576
    ds_read_b64_tr_b16 v[130:131], v213 offset:25088
    v_mfma_f32_32x32x16_bf16 v[160:175], v[144:147], v[104:107], v[160:175]
    ds_read_b64_tr_b16 v[132:133], v213 offset:25600
    ds_read_b64_tr_b16 v[134:135], v213 offset:26112
    s_and_b32 s29, s29, 0x380
    s_add_u32 m0, s35, 0
    s_mul_i32 s34, s29, 1536
    buffer_load_dwordx4 v212, s[8:11], s34 offen lds
    v_mfma_f32_32x32x16_bf16 v[176:191], v[104:107], v[148:151], v[176:191]
    ds_read_b128 v[116:119], v217 offset:24576
    ds_read_b64_tr_b16 v[136:137], v213 offset:28672
    ds_read_b64_tr_b16 v[138:139], v213 offset:29184
    v_mfma_f32_32x32x16_bf16 v[160:175], v[152:155], v[108:111], v[160:175]
    ds_read_b64_tr_b16 v[140:141], v213 offset:29696
    ds_read_b64_tr_b16 v[142:143], v213 offset:30208
    s_addk_i32 s29, 128
    buffer_load_dwordx4 v211, s[8:11], s34 offen offset:1024 lds
    v_mfma_f32_32x32x16_bf16 v[176:191], v[108:111], v[156:159], v[176:191]
    ds_read_b128 v[120:123], v218 offset:24576
    ds_read_b64_tr_b16 v[144:145], v213 offset:32768
    ds_read_b64_tr_b16 v[146:147], v213 offset:33280
    s_and_b32 s29, s29, 0x380
    s_add_u32 m0, s35, 8192
    s_mul_i32 s34, s29, 1536
    buffer_load_dwordx4 v212, s[8:11], s34 offen lds
    s_waitcnt lgkmcnt(8)
    v_mfma_f32_32x32x16_bf16 v[160:175], v[128:131], v[112:115], v[160:175]
    ds_read_b64_tr_b16 v[148:149], v213 offset:33792
    ds_read_b64_tr_b16 v[150:151], v213 offset:34304
    s_addk_i32 s29, 128
    buffer_load_dwordx4 v211, s[8:11], s34 offen offset:1024 lds
    v_mfma_f32_32x32x16_bf16 v[176:191], v[112:115], v[132:135], v[176:191]
    ds_read_b128 v[124:127], v219 offset:24576
    ds_read_b64_tr_b16 v[152:153], v213 offset:36864
    ds_read_b64_tr_b16 v[154:155], v213 offset:37376
    s_waitcnt lgkmcnt(8)
    v_mfma_f32_32x32x16_bf16 v[160:175], v[136:139], v[116:119], v[160:175]
    ds_read_b64_tr_b16 v[156:157], v213 offset:37888
    ds_read_b64_tr_b16 v[158:159], v213 offset:38400
    s_and_b32 s29, s29, 0x380
    s_add_u32 m0, s35, 16384
    s_mul_i32 s34, s29, 1536
    buffer_load_dwordx4 v212, s[8:11], s34 offen lds
    v_mfma_f32_32x32x16_bf16 v[176:191], v[116:119], v[140:143], v[176:191]
    s_addk_i32 s29, 128
    buffer_load_dwordx4 v211, s[8:11], s34 offen offset:1024 lds
    s_waitcnt lgkmcnt(0)
    s_waitcnt vmcnt(6)
    s_barrier
    v_mfma_f32_32x32x16_bf16 v[160:175], v[144:147], v[120:123], v[160:175]
    s_and_b32 s29, s29, 0x380
    s_add_u32 m0, s35, 24576
    s_mul_i32 s34, s29, 1536
    buffer_load_dwordx4 v212, s[8:11], s34 offen lds
    ds_read_b64_tr_b16 v[128:129], v215 offset:0
    ds_read_b64_tr_b16 v[130:131], v215 offset:512
    v_mfma_f32_32x32x16_bf16 v[176:191], v[120:123], v[148:151], v[176:191]
    s_addk_i32 s29, 128
    buffer_load_dwordx4 v211, s[8:11], s34 offen offset:1024 lds
    ds_read_b64_tr_b16 v[132:133], v215 offset:2048
    ds_read_b64_tr_b16 v[134:135], v215 offset:2560
    v_mfma_f32_32x32x16_bf16 v[160:175], v[152:155], v[124:127], v[160:175]
    s_and_b32 s29, s29, 0x380
    s_add_u32 m0, s35, 32768
    s_mul_i32 s34, s29, 1536
    buffer_load_dwordx4 v212, s[8:11], s34 offen lds
    ds_read_b64_tr_b16 v[136:137], v215 offset:4096
    ds_read_b64_tr_b16 v[138:139], v215 offset:4608
    v_mfma_f32_32x32x16_bf16 v[176:191], v[124:127], v[156:159], v[176:191]
    s_addk_i32 s29, 128
    buffer_load_dwordx4 v211, s[8:11], s34 offen offset:1024 lds
    ds_read_b64_tr_b16 v[140:141], v215 offset:6144
    ds_read_b64_tr_b16 v[142:143], v215 offset:6656
    ds_read_b64_tr_b16 v[144:145], v215 offset:8192
    ds_read_b64_tr_b16 v[146:147], v215 offset:8704
    s_waitcnt lgkmcnt(8)
    v_mfma_f32_32x32x16_bf16 v[192:207], v[128:131], v[0:3], 0
    ds_read_b64_tr_b16 v[148:149], v215 offset:10240
    ds_read_b64_tr_b16 v[150:151], v215 offset:10752
    s_waitcnt lgkmcnt(8)
    v_mfma_f32_32x32x16_bf16 v[192:207], v[132:135], v[4:7], v[192:207]
    v_cvt_pk_bf16_f32 v160, v160, v161
    v_cvt_pk_bf16_f32 v161, v162, v163
    v_cvt_pk_bf16_f32 v162, v164, v165
    v_cvt_pk_bf16_f32 v163, v166, v167
    buffer_store_dwordx4 v[160:163], v240, s[20:23], s58 offen sc1
    ds_read_b64_tr_b16 v[152:153], v215 offset:12288
    ds_read_b64_tr_b16 v[154:155], v215 offset:12800
    s_waitcnt lgkmcnt(8)
    v_mfma_f32_32x32x16_bf16 v[192:207], v[136:139], v[8:11], v[192:207]
    v_cvt_pk_bf16_f32 v164, v168, v169
    v_cvt_pk_bf16_f32 v165, v170, v171
    v_cvt_pk_bf16_f32 v166, v172, v173
    v_cvt_pk_bf16_f32 v167, v174, v175
    buffer_store_dwordx4 v[164:167], v240, s[20:23], s59 offen sc1
    ds_read_b64_tr_b16 v[156:157], v215 offset:14336
    ds_read_b64_tr_b16 v[158:159], v215 offset:14848
    s_waitcnt lgkmcnt(8)
    v_mfma_f32_32x32x16_bf16 v[192:207], v[140:143], v[12:15], v[192:207]
    v_cvt_pk_bf16_f32 v191, v190, v191
    v_cvt_pk_bf16_f32 v190, v188, v189
    v_cvt_pk_bf16_f32 v189, v186, v187
    v_cvt_pk_bf16_f32 v188, v184, v185
    buffer_store_dwordx4 v[188:191], v220, s[20:23], s58 offen offset:1536 sc1
    ds_read_b64_tr_b16 v[128:129], v215 offset:16384
    ds_read_b64_tr_b16 v[130:131], v215 offset:16896
    s_waitcnt lgkmcnt(8)
    v_mfma_f32_32x32x16_bf16 v[192:207], v[144:147], v[16:19], v[192:207]
    v_cvt_pk_bf16_f32 v184, v176, v177
    v_cvt_pk_bf16_f32 v185, v178, v179
    v_cvt_pk_bf16_f32 v186, v180, v181
    v_cvt_pk_bf16_f32 v187, v182, v183
    buffer_store_dwordx4 v[184:187], v220, s[20:23], s58 offen offset:1024 sc1
    ds_read_b64_tr_b16 v[132:133], v215 offset:18432
    ds_read_b64_tr_b16 v[134:135], v215 offset:18944
    s_waitcnt lgkmcnt(8)
    v_mfma_f32_32x32x16_bf16 v[192:207], v[148:151], v[20:23], v[192:207]
    ds_read_b64_tr_b16 v[136:137], v215 offset:20480
    ds_read_b64_tr_b16 v[138:139], v215 offset:20992
    s_waitcnt lgkmcnt(8)
    v_mfma_f32_32x32x16_bf16 v[192:207], v[152:155], v[24:27], v[192:207]
    ds_read_b64_tr_b16 v[140:141], v215 offset:22528
    ds_read_b64_tr_b16 v[142:143], v215 offset:23040
    s_waitcnt lgkmcnt(8)
    v_mfma_f32_32x32x16_bf16 v[192:207], v[156:159], v[28:31], v[192:207]
    s_waitcnt vmcnt(8)
    s_barrier
    ds_read_b64_tr_b16 v[144:145], v214 offset:0
    ds_read_b64_tr_b16 v[146:147], v214 offset:512
    s_waitcnt lgkmcnt(8)
    v_mfma_f32_32x32x16_bf16 v[192:207], v[128:131], v[32:35], v[192:207]
    ds_write_b128 v221, v[160:163] offset:16384
    ds_read_b64_tr_b16 v[148:149], v214 offset:2048
    ds_read_b64_tr_b16 v[150:151], v214 offset:2560
    s_waitcnt lgkmcnt(9)
    v_mfma_f32_32x32x16_bf16 v[192:207], v[132:135], v[36:39], v[192:207]
    ds_read_b64_tr_b16 v[152:153], v214 offset:4096
    ds_read_b64_tr_b16 v[154:155], v214 offset:4608
    s_waitcnt lgkmcnt(9)
    v_mfma_f32_32x32x16_bf16 v[192:207], v[136:139], v[40:43], v[192:207]
    ds_write_b128 v221, v[164:167] offset:18432
    ds_read_b64_tr_b16 v[156:157], v214 offset:6144
    ds_read_b64_tr_b16 v[158:159], v214 offset:6656
    s_waitcnt lgkmcnt(10)
    v_mfma_f32_32x32x16_bf16 v[192:207], v[140:143], v[44:47], v[192:207]
    ds_read_b64_tr_b16 v[128:129], v214 offset:8192
    ds_read_b64_tr_b16 v[130:131], v214 offset:8704
    s_waitcnt lgkmcnt(10)
    v_mfma_f32_32x32x16_bf16 v[192:207], v[144:147], v[48:51], v[192:207]
    ds_write_b128 v222, v[184:187] offset:40960
    ds_read_b64_tr_b16 v[132:133], v214 offset:10240
    ds_read_b64_tr_b16 v[134:135], v214 offset:10752
    s_waitcnt lgkmcnt(10)
    v_mfma_f32_32x32x16_bf16 v[192:207], v[148:151], v[52:55], v[192:207]
    ds_read_b64_tr_b16 v[136:137], v214 offset:12288
    ds_read_b64_tr_b16 v[138:139], v214 offset:12800
    s_waitcnt lgkmcnt(10)
    v_mfma_f32_32x32x16_bf16 v[192:207], v[152:155], v[56:59], v[192:207]
    ds_write_b128 v222, v[188:191] offset:41472
    ds_read_b64_tr_b16 v[140:141], v214 offset:14336
    ds_read_b64_tr_b16 v[142:143], v214 offset:14848
    s_waitcnt lgkmcnt(10)
    v_mfma_f32_32x32x16_bf16 v[192:207], v[156:159], v[60:63], v[192:207]
    ds_read_b64_tr_b16 v[144:145], v214 offset:16384
    ds_read_b64_tr_b16 v[146:147], v214 offset:16896
    s_waitcnt lgkmcnt(10)
    v_mfma_f32_32x32x16_bf16 v[192:207], v[128:131], v[64:67], v[192:207]
    ds_read_b64_tr_b16 v[148:149], v214 offset:18432
    ds_read_b64_tr_b16 v[150:151], v214 offset:18944
    s_waitcnt lgkmcnt(9)
    v_mfma_f32_32x32x16_bf16 v[192:207], v[132:135], v[68:71], v[192:207]
    ds_read_b64_tr_b16 v[152:153], v214 offset:20480
    ds_read_b64_tr_b16 v[154:155], v214 offset:20992
    s_waitcnt lgkmcnt(9)
    v_mfma_f32_32x32x16_bf16 v[192:207], v[136:139], v[72:75], v[192:207]
    ds_read_b64_tr_b16 v[156:157], v214 offset:22528
    ds_read_b64_tr_b16 v[158:159], v214 offset:23040
    s_waitcnt lgkmcnt(8)
    v_mfma_f32_32x32x16_bf16 v[192:207], v[140:143], v[76:79], v[192:207]
    s_waitcnt vmcnt(4)
    s_barrier
    ds_read_b64_tr_b16 v[128:129], v214 offset:24576
    ds_read_b64_tr_b16 v[130:131], v214 offset:25088
    s_waitcnt lgkmcnt(8)
    v_mfma_f32_32x32x16_bf16 v[192:207], v[144:147], v[80:83], v[192:207]
    v_sub_f32 v168, v253, v224
    v_sub_f32 v169, v253, v225
    v_sub_f32 v170, v253, v226
    v_sub_f32 v171, v253, v227
    v_sub_f32 v172, v253, v228
    v_sub_f32 v173, v253, v229
    v_sub_f32 v174, v253, v230
    v_sub_f32 v175, v253, v231
    v_sub_f32 v176, v253, v232
    v_sub_f32 v177, v253, v233
    v_sub_f32 v178, v253, v234
    v_sub_f32 v179, v253, v235
    v_sub_f32 v180, v253, v236
    v_sub_f32 v181, v253, v237
    v_sub_f32 v182, v253, v238
    v_sub_f32 v183, v253, v239
    v_mov_b64 v[0:1], s[56:57]
    v_mov_b64 v[2:3], s[56:57]
    v_mov_b64 v[4:5], s[56:57]
    v_mov_b64 v[6:7], s[56:57]
    v_mov_b64 v[8:9], s[56:57]
    v_mov_b64 v[10:11], s[56:57]
    v_mov_b64 v[12:13], s[56:57]
    v_mov_b64 v[14:15], s[56:57]
    v_mov_b64 v[16:17], s[56:57]
    v_mov_b64 v[18:19], s[56:57]
    v_mov_b64 v[20:21], s[56:57]
    v_mov_b64 v[22:23], s[56:57]
    v_mov_b64 v[24:25], s[56:57]
    v_mov_b64 v[26:27], s[56:57]
    v_mov_b64 v[28:29], s[56:57]
    v_mov_b64 v[30:31], s[56:57]
    v_mov_b64 v[32:33], s[56:57]
    v_mov_b64 v[34:35], s[56:57]
    v_mov_b64 v[36:37], s[56:57]
    v_mov_b64 v[38:39], s[56:57]
    v_mov_b64 v[40:41], s[56:57]
    v_mov_b64 v[42:43], s[56:57]
    v_mov_b64 v[44:45], s[56:57]
    v_mov_b64 v[46:47], s[56:57]
    v_mov_b64 v[48:49], s[56:57]
    v_mov_b64 v[50:51], s[56:57]
    v_mov_b64 v[52:53], s[56:57]
    v_mov_b64 v[54:55], s[56:57]
    v_mov_b64 v[56:57], s[56:57]
    v_mov_b64 v[58:59], s[56:57]
    v_mov_b64 v[60:61], s[56:57]
    v_mov_b64 v[62:63], s[56:57]
    v_mov_b64 v[64:65], s[56:57]
    v_mov_b64 v[66:67], s[56:57]
    v_mov_b64 v[68:69], s[56:57]
    v_mov_b64 v[70:71], s[56:57]
    v_mov_b64 v[72:73], s[56:57]
    v_mov_b64 v[74:75], s[56:57]
    v_mov_b64 v[76:77], s[56:57]
    v_mov_b64 v[78:79], s[56:57]
    s_waitcnt vmcnt(0)
    s_barrier
    s_mov_b64 exec, 1
    buffer_store_dword v243, v223, s[20:23], 0 offen sc1
    s_mov_b64 exec, -1
    ds_read_b64_tr_b16 v[132:133], v214 offset:26624
    ds_read_b64_tr_b16 v[134:135], v214 offset:27136
    s_waitcnt lgkmcnt(8)
    v_mfma_f32_32x32x16_bf16 v[192:207], v[148:151], v[84:87], v[192:207]
    ds_read_b64_tr_b16 v[136:137], v214 offset:28672
    ds_read_b64_tr_b16 v[138:139], v214 offset:29184
    s_waitcnt lgkmcnt(8)
    v_mfma_f32_32x32x16_bf16 v[192:207], v[152:155], v[88:91], v[192:207]
    ds_read_b64_tr_b16 v[140:141], v214 offset:30720
    ds_read_b64_tr_b16 v[142:143], v214 offset:31232
    s_waitcnt lgkmcnt(8)
    v_mfma_f32_32x32x16_bf16 v[192:207], v[156:159], v[92:95], v[192:207]
    ds_read_b64_tr_b16 v[144:145], v214 offset:32768
    ds_read_b64_tr_b16 v[146:147], v214 offset:33280
    s_waitcnt lgkmcnt(8)
    v_mfma_f32_32x32x16_bf16 v[192:207], v[128:131], v[96:99], v[192:207]
    ds_read_b64_tr_b16 v[148:149], v214 offset:34816
    ds_read_b64_tr_b16 v[150:151], v214 offset:35328
    s_waitcnt lgkmcnt(8)
    v_mfma_f32_32x32x16_bf16 v[192:207], v[132:135], v[100:103], v[192:207]
    ds_read_b64_tr_b16 v[152:153], v214 offset:36864
    ds_read_b64_tr_b16 v[154:155], v214 offset:37376
    s_waitcnt lgkmcnt(8)
    v_mfma_f32_32x32x16_bf16 v[192:207], v[136:139], v[104:107], v[192:207]
    ds_read_b64_tr_b16 v[156:157], v214 offset:38912
    ds_read_b64_tr_b16 v[158:159], v214 offset:39424
    s_waitcnt lgkmcnt(8)
    v_mfma_f32_32x32x16_bf16 v[192:207], v[140:143], v[108:111], v[192:207]
    s_waitcnt lgkmcnt(6)
    v_mfma_f32_32x32x16_bf16 v[192:207], v[144:147], v[112:115], v[192:207]
    s_waitcnt lgkmcnt(4)
    v_mfma_f32_32x32x16_bf16 v[192:207], v[148:151], v[116:119], v[192:207]
    s_waitcnt lgkmcnt(2)
    v_mfma_f32_32x32x16_bf16 v[192:207], v[152:155], v[120:123], v[192:207]
    s_waitcnt lgkmcnt(0)
    v_mfma_f32_32x32x16_bf16 v[192:207], v[156:159], v[124:127], v[192:207]
    buffer_load_dword v254, v248, s[20:23], 0 offen sc1
    s_mov_b64 exec, s[48:49]
    ds_read_b128 v[64:67], v251 offset:40960
    ds_read_b128 v[68:71], v251 offset:41472
    ds_read_b128 v[72:75], v251 offset:41984
    ds_read_b128 v[76:79], v251 offset:42496
    s_mov_b64 exec, -1
    ds_read_b128 v[112:115], v250 offset:16384
    ds_read_b128 v[116:119], v250 offset:17408
    s_nop 3
    v_mul_f32 v192, s31, v192
    v_mul_f32 v193, s31, v193
    v_mul_f32 v194, s31, v194
    v_mul_f32 v195, s31, v195
    v_mul_f32 v196, s31, v196
    v_mul_f32 v197, s31, v197
    v_mul_f32 v198, s31, v198
    v_mul_f32 v199, s31, v199
    v_cvt_pk_bf16_f32 v128, v192, v193
    v_cvt_pk_bf16_f32 v129, v194, v195
    v_cvt_pk_bf16_f32 v130, v196, v197
    v_cvt_pk_bf16_f32 v131, v198, v199
    ds_write_b128 v255, v[128:131] offset:0
    v_mul_f32 v200, s31, v200
    v_mul_f32 v201, s31, v201
    v_mul_f32 v202, s31, v202
    v_mul_f32 v203, s31, v203
    v_mul_f32 v204, s31, v204
    v_mul_f32 v205, s31, v205
    v_mul_f32 v206, s31, v206
    v_mul_f32 v207, s31, v207
    v_cvt_pk_bf16_f32 v132, v200, v201
    v_cvt_pk_bf16_f32 v133, v202, v203
    v_cvt_pk_bf16_f32 v134, v204, v205
    v_cvt_pk_bf16_f32 v135, v206, v207
    ds_write_b128 v255, v[132:135] offset:2048
    s_waitcnt lgkmcnt(0)
    s_barrier
    ds_read_b128 v[124:127], v252 offset:50176
    ds_read_b128 v[120:123], v252 offset:49152
    v_and_b32 v253, 7, v241
    v_lshrrev_b32 v250, 3, v241
    v_lshlrev_b32 v184, 4, v253
    v_lshl_add_u32 v184, v250, 11, v184
    v_lshlrev_b32 v253, 11, v253
    v_lshl_add_u32 v253, v250, 16, v253
    s_lshl2_add_u32 s29, s25, s28
    s_lshl_b32 s29, s29, 12
    v_lshlrev_b32 v185, 10, v241
    s_waitcnt lgkmcnt(1)
    v_mfma_f32_32x32x16_bf16 v[128:143], v[116:119], v[124:127], v[224:239]
    s_mov_b32 s37, 200000
L_b_poll2:
    s_waitcnt vmcnt(0)
    v_cmp_ne_u32 vcc, s43, v254
    s_sub_u32 s37, s37, 1
    s_and_b64 vcc, vcc, s[38:39]
    s_cbranch_scc0 L_b_poll2_x
    s_sleep 1
    buffer_load_dword v254, v248, s[20:23], 0 offen sc1
    s_cmp_lg_u32 s37, 0
    s_cbranch_scc1 L_b_poll2
    s_waitcnt vmcnt(0)
L_b_poll2_x:
    buffer_load_dwordx4 v[108:111], v240, s[20:23], s51 offen offset:2048 sc1
    s_mov_b64 exec, s[48:49]
    buffer_load_dwordx4 v[56:59], v242, s[20:23], s51 offen offset:3072 sc1
    buffer_load_dwordx4 v[60:63], v242, s[20:23], s51 offen offset:3584 sc1
    buffer_load_dwordx4 v[48:51], v242, s[20:23], s51 offen offset:1024 sc1
    buffer_load_dwordx4 v[52:55], v242, s[20:23], s51 offen offset:1536 sc1
    s_mov_b64 exec, -1
    buffer_load_dwordx4 v[104:107], v240, s[20:23], s51 offen offset:0 sc1
    s_addk_i32 s51, -4096
    s_waitcnt lgkmcnt(0)
    v_exp_f32 v128, v128
    v_exp_f32 v129, v129
    v_exp_f32 v130, v130
    v_cvt_pk_bf16_f32 v160, v128, v129
    v_exp_f32 v131, v131
    v_exp_f32 v132, v132
    v_cvt_pk_bf16_f32 v161, v130, v131
    v_mfma_f32_32x32x16_bf16 v[144:159], v[112:115], v[120:123], v[224:239]
    v_exp_f32 v133, v133
    v_exp_f32 v134, v134
    v_cvt_pk_bf16_f32 v162, v132, v133
    s_mov_b64 exec, 0xf
    buffer_load_dword v186, v185, s[12:15], s29 offen offset:384
    s_mov_b64 exec, -1
    v_exp_f32 v135, v135
    v_exp_f32 v136, v136
    v_cvt_pk_bf16_f32 v163, v134, v135
    v_exp_f32 v137, v137
    v_exp_f32 v138, v138
    v_mfma_f32_32x32x16_bf16 v[208:223], v[72:75], v[160:163], 0
    v_cvt_pk_bf16_f32 v164, v136, v137
    v_exp_f32 v139, v139
    v_exp_f32 v140, v140
    v_cvt_pk_bf16_f32 v165, v138, v139
    v_exp_f32 v141, v141
    v_exp_f32 v142, v142
    v_cvt_pk_bf16_f32 v166, v140, v141
    v_exp_f32 v143, v143
    v_exp_f32 v144, v144
    v_cvt_pk_bf16_f32 v167, v142, v143
    v_exp_f32 v145, v145
    v_exp_f32 v146, v146
    v_mfma_f32_32x32x16_bf16 v[208:223], v[76:79], v[164:167], v[208:223]
    v_cvt_pk_bf16_f32 v160, v144, v145
    v_exp_f32 v147, v147
    v_exp_f32 v148, v148
    v_cvt_pk_bf16_f32 v161, v146, v147
    v_mfma_f32_32x32x16_bf16 v[128:143], v[112:115], v[124:127], 0
    v_exp_f32 v149, v149
    v_exp_f32 v150, v150
    v_cvt_pk_bf16_f32 v162, v148, v149
    v_exp_f32 v151, v151
    v_exp_f32 v152, v152
    v_cvt_pk_bf16_f32 v163, v150, v151
    v_exp_f32 v153, v153
    v_exp_f32 v154, v154
    v_mfma_f32_32x32x16_bf16 v[192:207], v[64:67], v[160:163], 0
    v_cvt_pk_bf16_f32 v164, v152, v153
    v_exp_f32 v155, v155
    v_exp_f32 v156, v156
    v_cvt_pk_bf16_f32 v165, v154, v155
    v_exp_f32 v157, v157
    v_exp_f32 v158, v158
    v_cvt_pk_bf16_f32 v166, v156, v157
    v_exp_f32 v159, v159
    v_exp_f32 v128, v128
    v_cvt_pk_bf16_f32 v167, v158, v159
    v_exp_f32 v129, v129
    v_exp_f32 v130, v130
    v_mfma_f32_32x32x16_bf16 v[192:207], v[68:71], v[164:167], v[192:207]
    v_cvt_pk_bf16_f32 v160, v128, v129
    v_exp_f32 v131, v131
    v_exp_f32 v132, v132
    v_cvt_pk_bf16_f32 v161, v130, v131
    s_waitcnt vmcnt(6)
    v_mfma_f32_32x32x16_bf16 v[144:159], v[108:111], v[120:123], 0
    v_exp_f32 v133, v133
    v_exp_f32 v134, v134
    v_cvt_pk_bf16_f32 v162, v132, v133
    s_barrier
    buffer_load_dwordx4 v[100:103], v240, s[20:23], s51 offen offset:2048 sc1
    buffer_load_dwordx4 v[96:99], v240, s[20:23], s51 offen offset:0 sc1
    s_mov_b64 exec, s[48:49]
    buffer_load_dwordx4 v[40:43], v242, s[20:23], s51 offen offset:3072 sc1
    buffer_load_dwordx4 v[44:47], v242, s[20:23], s51 offen offset:3584 sc1
    buffer_load_dwordx4 v[32:35], v242, s[20:23], s51 offen offset:1024 sc1
    buffer_load_dwordx4 v[36:39], v242, s[20:23], s51 offen offset:1536 sc1
    s_mov_b64 exec, -1
    s_addk_i32 s51, -4096
    v_exp_f32 v135, v135
    v_exp_f32 v136, v136
    v_cvt_pk_bf16_f32 v163, v134, v135
    v_exp_f32 v137, v137
    v_exp_f32 v138, v138
    v_mfma_f32_32x32x16_bf16 v[208:223], v[64:67], v[160:163], v[208:223]
    v_cvt_pk_bf16_f32 v164, v136, v137
    v_exp_f32 v139, v139
    v_exp_f32 v140, v140
    v_cvt_pk_bf16_f32 v165, v138, v139
    v_exp_f32 v141, v141
    v_exp_f32 v142, v142
    v_cvt_pk_bf16_f32 v166, v140, v141
    v_exp_f32 v143, v143
    s_cmp_eq_u32 s44, 0
    s_cbranch_scc1 L_b_fx0
    v_exp_f32 v144, v144
    v_cvt_pk_bf16_f32 v167, v142, v143
    v_exp_f32 v145, v145
    v_exp_f32 v146, v146
    v_mfma_f32_32x32x16_bf16 v[208:223], v[68:71], v[164:167], v[208:223]
    v_cvt_pk_bf16_f32 v160, v144, v145
    v_exp_f32 v147, v147
    v_exp_f32 v148, v148
    v_cvt_pk_bf16_f32 v161, v146, v147
    v_mfma_f32_32x32x16_bf16 v[128:143], v[108:111], v[124:127], 0
    v_exp_f32 v149, v149
    v_exp_f32 v150, v150
    v_cvt_pk_bf16_f32 v162, v148, v149
    v_exp_f32 v151, v151
    v_exp_f32 v152, v152
    v_cvt_pk_bf16_f32 v163, v150, v151
    v_exp_f32 v153, v153
    v_exp_f32 v154, v154
    s_waitcnt vmcnt(10)
    v_mfma_f32_32x32x16_bf16 v[192:207], v[56:59], v[160:163], v[192:207]
    v_cvt_pk_bf16_f32 v164, v152, v153
    v_exp_f32 v155, v155
    v_exp_f32 v156, v156
    v_cvt_pk_bf16_f32 v165, v154, v155
    v_exp_f32 v157, v157
    v_exp_f32 v158, v158
    v_cvt_pk_bf16_f32 v166, v156, v157
    v_exp_f32 v159, v159
    v_exp_f32 v128, v128
    v_cvt_pk_bf16_f32 v167, v158, v159
    v_exp_f32 v129, v129
    v_exp_f32 v130, v130
    v_mfma_f32_32x32x16_bf16 v[192:207], v[60:63], v[164:167], v[192:207]
    v_cvt_pk_bf16_f32 v160, v128, v129
    v_exp_f32 v131, v131
    v_exp_f32 v132, v132
    v_cvt_pk_bf16_f32 v161, v130, v131
    s_waitcnt vmcnt(7)
    v_mfma_f32_32x32x16_bf16 v[144:159], v[104:107], v[120:123], 0
    v_exp_f32 v133, v133
    v_exp_f32 v134, v134
    v_cvt_pk_bf16_f32 v162, v132, v133
    s_add_u32 m0, s52, 0
    s_add_u32 s32, s53, 0
    buffer_load_dwordx4 v244, s[12:15], s32 offen lds
    buffer_load_dwordx4 v245, s[12:15], s32 offen offset:1024 lds
    buffer_load_dwordx4 v246, s[12:15], s32 offen offset:2048 lds
    buffer_load_dwordx4 v247, s[12:15], s32 offen offset:3072 lds
    v_exp_f32 v135, v135
    v_exp_f32 v136, v136
    v_cvt_pk_bf16_f32 v163, v134, v135
    v_exp_f32 v137, v137
    v_exp_f32 v138, v138
    v_mfma_f32_32x32x16_bf16 v[208:223], v[56:59], v[160:163], v[208:223]
    v_cvt_pk_bf16_f32 v164, v136, v137
    v_exp_f32 v139, v139
    v_exp_f32 v140, v140
    v_cvt_pk_bf16_f32 v165, v138, v139
    v_exp_f32 v141, v141
    v_exp_f32 v142, v142
    v_cvt_pk_bf16_f32 v166, v140, v141
    v_exp_f32 v143, v143
    v_exp_f32 v144, v144
    v_cvt_pk_bf16_f32 v167, v142, v143
    v_exp_f32 v145, v145
    v_exp_f32 v146, v146
    v_mfma_f32_32x32x16_bf16 v[208:223], v[60:63], v[164:167], v[208:223]
    v_cvt_pk_bf16_f32 v160, v144, v145
    v_exp_f32 v147, v147
    v_exp_f32 v148, v148
    v_cvt_pk_bf16_f32 v161, v146, v147
    v_mfma_f32_32x32x16_bf16 v[128:143], v[104:107], v[124:127], 0
    v_exp_f32 v149, v149
    v_exp_f32 v150, v150
    v_cvt_pk_bf16_f32 v162, v148, v149
    buffer_load_dwordx4 v[92:95], v240, s[20:23], s51 offen offset:2048 sc1
    buffer_load_dwordx4 v[88:91], v240, s[20:23], s51 offen offset:0 sc1
    s_mov_b64 exec, s[48:49]
    buffer_load_dwordx4 v[24:27], v242, s[20:23], s51 offen offset:3072 sc1
    buffer_load_dwordx4 v[28:31], v242, s[20:23], s51 offen offset:3584 sc1
    buffer_load_dwordx4 v[16:19], v242, s[20:23], s51 offen offset:1024 sc1
    buffer_load_dwordx4 v[20:23], v242, s[20:23], s51 offen offset:1536 sc1
    s_mov_b64 exec, -1
    s_addk_i32 s51, -4096
    v_exp_f32 v151, v151
    v_exp_f32 v152, v152
    v_cvt_pk_bf16_f32 v163, v150, v151
    v_exp_f32 v153, v153
    v_exp_f32 v154, v154
    v_mfma_f32_32x32x16_bf16 v[192:207], v[48:51], v[160:163], v[192:207]
    v_cvt_pk_bf16_f32 v164, v152, v153
    v_exp_f32 v155, v155
    v_exp_f32 v156, v156
    v_cvt_pk_bf16_f32 v165, v154, v155
    v_exp_f32 v157, v157
    v_exp_f32 v158, v158
    v_cvt_pk_bf16_f32 v166, v156, v157
    v_exp_f32 v159, v159
    v_exp_f32 v128, v128
    v_cvt_pk_bf16_f32 v167, v158, v159
    v_exp_f32 v129, v129
    v_exp_f32 v130, v130
    v_mfma_f32_32x32x16_bf16 v[192:207], v[52:55], v[164:167], v[192:207]
    v_cvt_pk_bf16_f32 v160, v128, v129
    v_exp_f32 v131, v131
    v_exp_f32 v132, v132
    v_cvt_pk_bf16_f32 v161, v130, v131
    s_waitcnt vmcnt(12)
    v_mfma_f32_32x32x16_bf16 v[144:159], v[100:103], v[120:123], 0
    v_exp_f32 v133, v133
    v_exp_f32 v134, v134
    v_cvt_pk_bf16_f32 v162, v132, v133
    s_mov_b64 exec, 0xffff
    buffer_load_dword v254, v253, s[16:19], s45 offen sc1
    s_mov_b64 exec, -1
    v_exp_f32 v135, v135
    v_exp_f32 v136, v136
    v_cvt_pk_bf16_f32 v163, v134, v135
    v_exp_f32 v137, v137
    v_exp_f32 v138, v138
    v_mfma_f32_32x32x16_bf16 v[208:223], v[48:51], v[160:163], v[208:223]
    v_cvt_pk_bf16_f32 v164, v136, v137
    v_exp_f32 v139, v139
    v_exp_f32 v140, v140
    v_cvt_pk_bf16_f32 v165, v138, v139
    v_exp_f32 v141, v141
    v_exp_f32 v142, v142
    v_cvt_pk_bf16_f32 v166, v140, v141
    v_exp_f32 v143, v143
    s_cmp_eq_u32 s44, 1
    s_cbranch_scc1 L_b_fx1
    v_exp_f32 v144, v144
    v_cvt_pk_bf16_f32 v167, v142, v143
    v_exp_f32 v145, v145
    v_exp_f32 v146, v146
    v_mfma_f32_32x32x16_bf16 v[208:223], v[52:55], v[164:167], v[208:223]
    v_cvt_pk_bf16_f32 v160, v144, v145
    v_exp_f32 v147, v147
    v_exp_f32 v148, v148
    v_cvt_pk_bf16_f32 v161, v146, v147
    v_mfma_f32_32x32x16_bf16 v[128:143], v[100:103], v[124:127], 0
    v_exp_f32 v149, v149
    v_exp_f32 v150, v150
    v_cvt_pk_bf16_f32 v162, v148, v149
    v_exp_f32 v151, v151
    v_exp_f32 v152, v152
    v_cvt_pk_bf16_f32 v163, v150, v151
    v_exp_f32 v153, v153
    v_exp_f32 v154, v154
    v_mfma_f32_32x32x16_bf16 v[192:207], v[40:43], v[160:163], v[192:207]
    v_cvt_pk_bf16_f32 v164, v152, v153
    v_exp_f32 v155, v155
    v_exp_f32 v156, v156
    v_cvt_pk_bf16_f32 v165, v154, v155
    v_exp_f32 v157, v157
    v_exp_f32 v158, v158
    v_cvt_pk_bf16_f32 v166, v156, v157
    v_exp_f32 v159, v159
    v_exp_f32 v128, v128
    v_cvt_pk_bf16_f32 v167, v158, v159
    v_exp_f32 v129, v129
    v_exp_f32 v130, v130
    v_mfma_f32_32x32x16_bf16 v[192:207], v[44:47], v[164:167], v[192:207]
    v_cvt_pk_bf16_f32 v160, v128, v129
    v_exp_f32 v131, v131
    v_exp_f32 v132, v132
    v_cvt_pk_bf16_f32 v161, v130, v131
    s_waitcnt vmcnt(11)
    v_mfma_f32_32x32x16_bf16 v[144:159], v[96:99], v[120:123], 0
    v_exp_f32 v133, v133
    v_exp_f32 v134, v134
    v_cvt_pk_bf16_f32 v162, v132, v133
    buffer_load_dwordx4 v[84:87], v240, s[20:23], s51 offen offset:2048 sc1
    buffer_load_dwordx4 v[80:83], v240, s[20:23], s51 offen offset:0 sc1
    s_mov_b64 exec, s[48:49]
    buffer_load_dwordx4 v[8:11], v242, s[20:23], s51 offen offset:3072 sc1
    buffer_load_dwordx4 v[12:15], v242, s[20:23], s51 offen offset:3584 sc1
    buffer_load_dwordx4 v[0:3], v242, s[20:23], s51 offen offset:1024 sc1
    buffer_load_dwordx4 v[4:7], v242, s[20:23], s51 offen offset:1536 sc1
    s_mov_b64 exec, -1
    v_exp_f32 v135, v135
    v_exp_f32 v136, v136
    v_cvt_pk_bf16_f32 v163, v134, v135
    v_exp_f32 v137, v137
    v_exp_f32 v138, v138
    v_mfma_f32_32x32x16_bf16 v[208:223], v[40:43], v[160:163], v[208:223]
    v_cvt_pk_bf16_f32 v164, v136, v137
    v_exp_f32 v139, v139
    v_exp_f32 v140, v140
    v_cvt_pk_bf16_f32 v165, v138, v139
    v_exp_f32 v141, v141
    v_exp_f32 v142, v142
    v_cvt_pk_bf16_f32 v166, v140, v141
    v_exp_f32 v143, v143
    v_exp_f32 v144, v144
    v_cvt_pk_bf16_f32 v167, v142, v143
    v_exp_f32 v145, v145
    v_exp_f32 v146, v146
    v_mfma_f32_32x32x16_bf16 v[208:223], v[44:47], v[164:167], v[208:223]
    v_cvt_pk_bf16_f32 v160, v144, v145
    v_exp_f32 v147, v147
    v_exp_f32 v148, v148
    v_cvt_pk_bf16_f32 v161, v146, v147
    v_mfma_f32_32x32x16_bf16 v[128:143], v[96:99], v[124:127], 0
    v_exp_f32 v149, v149
    v_exp_f32 v150, v150
    v_cvt_pk_bf16_f32 v162, v148, v149
    v_exp_f32 v151, v151
    v_exp_f32 v152, v152
    v_cvt_pk_bf16_f32 v163, v150, v151
    v_exp_f32 v153, v153
    v_exp_f32 v154, v154
    v_mfma_f32_32x32x16_bf16 v[192:207], v[32:35], v[160:163], v[192:207]
    v_cvt_pk_bf16_f32 v164, v152, v153
    v_exp_f32 v155, v155
    v_exp_f32 v156, v156
    v_cvt_pk_bf16_f32 v165, v154, v155
    v_exp_f32 v157, v157
    v_exp_f32 v158, v158
    v_cvt_pk_bf16_f32 v166, v156, v157
    v_exp_f32 v159, v159
    v_exp_f32 v128, v128
    v_cvt_pk_bf16_f32 v167, v158, v159
    v_exp_f32 v129, v129
    v_exp_f32 v130, v130
    v_mfma_f32_32x32x16_bf16 v[192:207], v[36:39], v[164:167], v[192:207]
    v_cvt_pk_bf16_f32 v160, v128, v129
    v_exp_f32 v131, v131
    v_exp_f32 v132, v132
    v_cvt_pk_bf16_f32 v161, v130, v131
    s_waitcnt vmcnt(9)
    v_mfma_f32_32x32x16_bf16 v[144:159], v[92:95], v[120:123], 0
    v_exp_f32 v133, v133
    v_exp_f32 v134, v134
    v_cvt_pk_bf16_f32 v162, v132, v133
    s_add_u32 m0, s52, 4096
    s_add_u32 s32, s53, 32768
    buffer_load_dwordx4 v244, s[12:15], s32 offen lds
    buffer_load_dwordx4 v245, s[12:15], s32 offen offset:1024 lds
    buffer_load_dwordx4 v246, s[12:15], s32 offen offset:2048 lds
    buffer_load_dwordx4 v247, s[12:15], s32 offen offset:3072 lds
    v_exp_f32 v135, v135
    v_exp_f32 v136, v136
    v_cvt_pk_bf16_f32 v163, v134, v135
    v_exp_f32 v137, v137
    v_exp_f32 v138, v138
    v_mfma_f32_32x32x16_bf16 v[208:223], v[32:35], v[160:163], v[208:223]
    v_cvt_pk_bf16_f32 v164, v136, v137
    v_exp_f32 v139, v139
    v_exp_f32 v140, v140
    v_cvt_pk_bf16_f32 v165, v138, v139
    v_exp_f32 v141, v141
    v_exp_f32 v142, v142
    v_cvt_pk_bf16_f32 v166, v140, v141
    v_exp_f32 v143, v143
    s_cmp_eq_u32 s44, 2
    s_cbranch_scc1 L_b_fx2
    v_exp_f32 v144, v144
    v_cvt_pk_bf16_f32 v167, v142, v143
    v_exp_f32 v145, v145
    v_exp_f32 v146, v146
    v_mfma_f32_32x32x16_bf16 v[208:223], v[36:39], v[164:167], v[208:223]
    v_cvt_pk_bf16_f32 v160, v144, v145
    v_exp_f32 v147, v147
    v_exp_f32 v148, v148
    v_cvt_pk_bf16_f32 v161, v146, v147
    v_mfma_f32_32x32x16_bf16 v[128:143], v[92:95], v[124:127], 0
    v_exp_f32 v149, v149
    v_exp_f32 v150, v150
    v_cvt_pk_bf16_f32 v162, v148, v149
    v_exp_f32 v151, v151
    v_exp_f32 v152, v152
    v_cvt_pk_bf16_f32 v163, v150, v151
    v_exp_f32 v153, v153
    v_exp_f32 v154, v154
    v_mfma_f32_32x32x16_bf16 v[192:207], v[24:27], v[160:163], v[192:207]
    v_cvt_pk_bf16_f32 v164, v152, v153
    v_exp_f32 v155, v155
    v_exp_f32 v156, v156
    v_cvt_pk_bf16_f32 v165, v154, v155
    v_exp_f32 v157, v157
    v_exp_f32 v158, v158
    v_cvt_pk_bf16_f32 v166, v156, v157
    v_exp_f32 v159, v159
    v_exp_f32 v128, v128
    v_cvt_pk_bf16_f32 v167, v158, v159
    v_exp_f32 v129, v129
    v_exp_f32 v130, v130
    v_mfma_f32_32x32x16_bf16 v[192:207], v[28:31], v[164:167], v[192:207]
    v_cvt_pk_bf16_f32 v160, v128, v129
    v_exp_f32 v131, v131
    v_exp_f32 v132, v132
    v_cvt_pk_bf16_f32 v161, v130, v131
    s_waitcnt vmcnt(11)
    v_mfma_f32_32x32x16_bf16 v[144:159], v[88:91], v[120:123], 0
    v_exp_f32 v133, v133
    v_exp_f32 v134, v134
    v_cvt_pk_bf16_f32 v162, v132, v133
    s_add_u32 m0, s52, 8192
    s_add_u32 s32, s53, 65536
    buffer_load_dwordx4 v244, s[12:15], s32 offen lds
    buffer_load_dwordx4 v245, s[12:15], s32 offen offset:1024 lds
    buffer_load_dwordx4 v246, s[12:15], s32 offen offset:2048 lds
    buffer_load_dwordx4 v247, s[12:15], s32 offen offset:3072 lds
    v_exp_f32 v135, v135
    v_exp_f32 v136, v136
    v_cvt_pk_bf16_f32 v163, v134, v135
    v_exp_f32 v137, v137
    v_exp_f32 v138, v138
    v_mfma_f32_32x32x16_bf16 v[208:223], v[24:27], v[160:163], v[208:223]
    v_cvt_pk_bf16_f32 v164, v136, v137
    v_exp_f32 v139, v139
    v_exp_f32 v140, v140
    v_cvt_pk_bf16_f32 v165, v138, v139
    v_exp_f32 v141, v141
    v_exp_f32 v142, v142
    v_cvt_pk_bf16_f32 v166, v140, v141
    v_exp_f32 v143, v143
    v_exp_f32 v144, v144
    v_cvt_pk_bf16_f32 v167, v142, v143
    v_exp_f32 v145, v145
    v_exp_f32 v146, v146
    v_mfma_f32_32x32x16_bf16 v[208:223], v[28:31], v[164:167], v[208:223]
    v_cvt_pk_bf16_f32 v160, v144, v145
    v_exp_f32 v147, v147
    v_exp_f32 v148, v148
    v_cvt_pk_bf16_f32 v161, v146, v147
    v_mfma_f32_32x32x16_bf16 v[128:143], v[88:91], v[124:127], 0
    v_exp_f32 v149, v149
    v_exp_f32 v150, v150
    v_cvt_pk_bf16_f32 v162, v148, v149
    v_exp_f32 v151, v151
    v_exp_f32 v152, v152
    v_cvt_pk_bf16_f32 v163, v150, v151
    v_exp_f32 v153, v153
    v_exp_f32 v154, v154
    v_mfma_f32_32x32x16_bf16 v[192:207], v[16:19], v[160:163], v[192:207]
    v_cvt_pk_bf16_f32 v164, v152, v153
    v_exp_f32 v155, v155
    v_exp_f32 v156, v156
    v_cvt_pk_bf16_f32 v165, v154, v155
    v_exp_f32 v157, v157
    v_exp_f32 v158, v158
    v_cvt_pk_bf16_f32 v166, v156, v157
    v_exp_f32 v159, v159
    v_exp_f32 v128, v128
    v_cvt_pk_bf16_f32 v167, v158, v159
    v_exp_f32 v129, v129
    v_exp_f32 v130, v130
    v_mfma_f32_32x32x16_bf16 v[192:207], v[20:23], v[164:167], v[192:207]
    v_cvt_pk_bf16_f32 v160, v128, v129
    v_exp_f32 v131, v131
    v_exp_f32 v132, v132
    v_cvt_pk_bf16_f32 v161, v130, v131
    s_waitcnt vmcnt(10)
    v_mfma_f32_32x32x16_bf16 v[144:159], v[84:87], v[120:123], 0
    v_exp_f32 v133, v133
    v_exp_f32 v134, v134
    v_cvt_pk_bf16_f32 v162, v132, v133
    s_add_u32 m0, s52, 12288
    s_add_u32 s32, s53, 98304
    buffer_load_dwordx4 v244, s[12:15], s32 offen lds
    buffer_load_dwordx4 v245, s[12:15], s32 offen offset:1024 lds
    buffer_load_dwordx4 v246, s[12:15], s32 offen offset:2048 lds
    buffer_load_dwordx4 v247, s[12:15], s32 offen offset:3072 lds
    v_exp_f32 v135, v135
    v_exp_f32 v136, v136
    v_cvt_pk_bf16_f32 v163, v134, v135
    v_exp_f32 v137, v137
    v_exp_f32 v138, v138
    v_mfma_f32_32x32x16_bf16 v[208:223], v[16:19], v[160:163], v[208:223]
    v_cvt_pk_bf16_f32 v164, v136, v137
    v_exp_f32 v139, v139
    v_exp_f32 v140, v140
    v_cvt_pk_bf16_f32 v165, v138, v139
    v_exp_f32 v141, v141
    v_exp_f32 v142, v142
    v_cvt_pk_bf16_f32 v166, v140, v141
    v_exp_f32 v143, v143
    s_cmp_eq_u32 s44, 3
    s_cbranch_scc1 L_b_fx3
    v_exp_f32 v144, v144
    v_cvt_pk_bf16_f32 v167, v142, v143
    v_exp_f32 v145, v145
    v_exp_f32 v146, v146
    v_mfma_f32_32x32x16_bf16 v[208:223], v[20:23], v[164:167], v[208:223]
    v_cvt_pk_bf16_f32 v160, v144, v145
    v_exp_f32 v147, v147
    v_exp_f32 v148, v148
    v_cvt_pk_bf16_f32 v161, v146, v147
    v_mfma_f32_32x32x16_bf16 v[128:143], v[84:87], v[124:127], v[168:183]
    v_exp_f32 v149, v149
    v_exp_f32 v150, v150
    v_cvt_pk_bf16_f32 v162, v148, v149
    v_exp_f32 v151, v151
    v_exp_f32 v152, v152
    v_cvt_pk_bf16_f32 v163, v150, v151
    v_exp_f32 v153, v153
    v_exp_f32 v154, v154
    v_mfma_f32_32x32x16_bf16 v[192:207], v[8:11], v[160:163], v[192:207]
    v_cvt_pk_bf16_f32 v164, v152, v153
    v_exp_f32 v155, v155
    v_exp_f32 v156, v156
    v_cvt_pk_bf16_f32 v165, v154, v155
    v_exp_f32 v157, v157
    v_exp_f32 v158, v158
    v_cvt_pk_bf16_f32 v166, v156, v157
    v_exp_f32 v159, v159
    v_exp_f32 v128, v128
    v_cvt_pk_bf16_f32 v167, v158, v159
    v_exp_f32 v129, v129
    v_exp_f32 v130, v130
    v_mfma_f32_32x32x16_bf16 v[192:207], v[12:15], v[164:167], v[192:207]
    v_cvt_pk_bf16_f32 v160, v128, v129
    v_exp_f32 v131, v131
    v_exp_f32 v132, v132
    v_cvt_pk_bf16_f32 v161, v130, v131
    s_waitcnt vmcnt(12)
    v_mfma_f32_32x32x16_bf16 v[144:159], v[80:83], v[120:123], v[168:183]
    v_exp_f32 v133, v133
    v_exp_f32 v134, v134
    v_cvt_pk_bf16_f32 v162, v132, v133
    v_exp_f32 v135, v135
    v_exp_f32 v136, v136
    v_cvt_pk_bf16_f32 v163, v134, v135
    v_exp_f32 v137, v137
    v_exp_f32 v138, v138
    v_mfma_f32_32x32x16_bf16 v[208:223], v[8:11], v[160:163], v[208:223]
    v_cvt_pk_bf16_f32 v164, v136, v137
    v_exp_f32 v139, v139
    v_exp_f32 v140, v140
    v_cvt_pk_bf16_f32 v165, v138, v139
    v_exp_f32 v141, v141
    v_exp_f32 v142, v142
    v_cvt_pk_bf16_f32 v166, v140, v141
    v_exp_f32 v143, v143
    v_exp_f32 v144, v144
    v_cvt_pk_bf16_f32 v167, v142, v143
    v_exp_f32 v145, v145
    v_exp_f32 v146, v146
    v_mfma_f32_32x32x16_bf16 v[208:223], v[12:15], v[164:167], v[208:223]
    v_cvt_pk_bf16_f32 v160, v144, v145
    v_exp_f32 v147, v147
    v_exp_f32 v148, v148
    v_cvt_pk_bf16_f32 v161, v146, v147
    v_exp_f32 v149, v149
    v_exp_f32 v150, v150
    v_cvt_pk_bf16_f32 v162, v148, v149
    v_exp_f32 v151, v151
    v_exp_f32 v152, v152
    v_cvt_pk_bf16_f32 v163, v150, v151
    v_exp_f32 v153, v153
    v_exp_f32 v154, v154
    v_mfma_f32_32x32x16_bf16 v[192:207], v[0:3], v[160:163], v[192:207]
    v_cvt_pk_bf16_f32 v164, v152, v153
    v_exp_f32 v155, v155
    v_exp_f32 v156, v156
    v_cvt_pk_bf16_f32 v165, v154, v155
    v_exp_f32 v157, v157
    v_exp_f32 v158, v158
    v_cvt_pk_bf16_f32 v166, v156, v157
    v_exp_f32 v159, v159
    s_nop 0
    v_cvt_pk_bf16_f32 v167, v158, v159
    s_nop 1
    v_mfma_f32_32x32x16_bf16 v[192:207], v[4:7], v[164:167], v[192:207]
L_b_fdone:
    s_mov_b32 s30, 0x1f800000
    s_mov_b32 s31, 0x40000000
    v_subrev_u32 v250, s30, v216
    v_cmp_lt_u32 s[38:39], s31, v250
    v_rcp_f32 v251, v216
    s_nop 0
    v_mul_f32 v152, v251, v208
    v_mul_f32 v153, v251, v209
    v_mul_f32 v154, v251, v210
    v_mul_f32 v155, v251, v211
    v_mul_f32 v156, v251, v212
    v_mul_f32 v157, v251, v213
    v_mul_f32 v158, v251, v214
    v_mul_f32 v159, v251, v215
    v_subrev_u32 v250, s30, v200
    v_cmp_lt_u32 vcc, s31, v250
    v_rcp_f32 v252, v200
    s_or_b64 vcc, vcc, s[38:39]
    s_cbranch_scc1 L_b_slow
    v_cvt_pk_bf16_f32 v144, v152, v153
    v_cvt_pk_bf16_f32 v145, v154, v155
    v_cvt_pk_bf16_f32 v146, v156, v157
    v_cvt_pk_bf16_f32 v147, v158, v159
    buffer_store_dwordx4 v[144:147], v184, s[16:19], s33 offen
    v_mul_f32 v192, v252, v192
    v_mul_f32 v193, v252, v193
    v_mul_f32 v194, v252, v194
    v_mul_f32 v195, v252, v195
    v_mul_f32 v196, v252, v196
    v_mul_f32 v197, v252, v197
    v_mul_f32 v198, v252, v198
    v_mul_f32 v199, v252, v199
    v_cvt_pk_bf16_f32 v128, v192, v193
    v_cvt_pk_bf16_f32 v129, v194, v195
    v_cvt_pk_bf16_f32 v130, v196, v197
    v_cvt_pk_bf16_f32 v131, v198, v199
    buffer_store_dwordx4 v[128:131], v184, s[16:19], s45 offen
L_b_att_done:
    v_bfe_u32 v224, v241, 2, 2
    v_lshrrev_b32 v225, 5, v241
    v_lshl_add_u32 v224, v225, 2, v224
    v_lshlrev_b32 v224, 7, v224
    v_bfe_u32 v226, v241, 3, 1
    v_lshl_add_u32 v224, v226, 6, v224
    v_and_b32 v226, 1, v241
    v_lshl_add_u32 v224, v226, 5, v224
    v_bfe_u32 v226, v241, 4, 1
    v_lshl_add_u32 v224, v226, 4, v224
    v_bfe_u32 v226, v241, 1, 1
    v_lshl_add_u32 v224, v226, 3, v224
    s_lshr_b32 s31, s28, 1
    s_lshl_b32 s32, s31, 15
    v_add_u32 v224, s32, v224
    v_xor_b32 v226, 64, v224
    v_mov_b32 v252, s50
    v_mov_b32 v251, s46
    s_waitcnt vmcnt(2)
    s_barrier
    ds_read_b64_tr_b16 v[0:1], v224 offset:0
    ds_read_b64_tr_b16 v[2:3], v224 offset:1024
    ds_read_b64_tr_b16 v[4:5], v226 offset:0
    ds_read_b64_tr_b16 v[6:7], v226 offset:1024
    ds_read_b64_tr_b16 v[8:9], v224 offset:2048
    ds_read_b64_tr_b16 v[10:11], v224 offset:3072
    ds_read_b64_tr_b16 v[12:13], v226 offset:2048
    ds_read_b64_tr_b16 v[14:15], v226 offset:3072
    ds_read_b64_tr_b16 v[16:17], v224 offset:4096
    ds_read_b64_tr_b16 v[18:19], v224 offset:5120
    ds_read_b64_tr_b16 v[20:21], v226 offset:4096
    ds_read_b64_tr_b16 v[22:23], v226 offset:5120
    ds_read_b64_tr_b16 v[24:25], v224 offset:6144
    ds_read_b64_tr_b16 v[26:27], v224 offset:7168
    ds_read_b64_tr_b16 v[28:29], v226 offset:6144
    ds_read_b64_tr_b16 v[30:31], v226 offset:7168
    s_waitcnt vmcnt(0)
    s_mov_b64 exec, 1
    buffer_store_dword v251, v252, s[20:23], 0 offen
    s_mov_b64 exec, -1
    ds_read_b64_tr_b16 v[32:33], v224 offset:8192
    ds_read_b64_tr_b16 v[34:35], v224 offset:9216
    ds_read_b64_tr_b16 v[36:37], v226 offset:8192
    ds_read_b64_tr_b16 v[38:39], v226 offset:9216
    ds_read_b64_tr_b16 v[40:41], v224 offset:10240
    ds_read_b64_tr_b16 v[42:43], v224 offset:11264
    ds_read_b64_tr_b16 v[44:45], v226 offset:10240
    ds_read_b64_tr_b16 v[46:47], v226 offset:11264
    ds_read_b64_tr_b16 v[48:49], v224 offset:12288
    ds_read_b64_tr_b16 v[50:51], v224 offset:13312
    ds_read_b64_tr_b16 v[52:53], v226 offset:12288
    ds_read_b64_tr_b16 v[54:55], v226 offset:13312
    ds_read_b64_tr_b16 v[56:57], v224 offset:14336
    ds_read_b64_tr_b16 v[58:59], v224 offset:15360
    ds_read_b64_tr_b16 v[60:61], v226 offset:14336
    ds_read_b64_tr_b16 v[62:63], v226 offset:15360
    ds_read_b64_tr_b16 v[64:65], v224 offset:16384
    ds_read_b64_tr_b16 v[66:67], v224 offset:17408
    ds_read_b64_tr_b16 v[68:69], v226 offset:16384
    ds_read_b64_tr_b16 v[70:71], v226 offset:17408
    ds_read_b64_tr_b16 v[72:73], v224 offset:18432
    ds_read_b64_tr_b16 v[74:75], v224 offset:19456
    ds_read_b64_tr_b16 v[76:77], v226 offset:18432
    ds_read_b64_tr_b16 v[78:79], v226 offset:19456
    s_and_b32 s30, s28, 1
    s_lshl1_add_u32 s32, s26, s30
    s_lshl_b32 s32, s32, 16
    s_lshl_b32 s33, s31, 9
    s_xor_b32 s33, s33, 512
    s_add_u32 s32, s32, s33
    v_mov_b32 v253, v184
    s_add_u32 s45, s32, 1024
    s_add_u32 s51, s32, 17408
    s_add_u32 s52, s32, 33792
    s_add_u32 s53, s32, 50176
    s_mov_b32 s37, s47
L_b_poll4:
    buffer_load_dword v228, v249, s[20:23], 0 offen sc1
    s_waitcnt vmcnt(0)
    v_cmp_ne_u32 vcc, s46, v228
    s_sub_u32 s37, s37, 1
    s_cmp_lg_u64 vcc, 0
    s_cbranch_scc0 L_b_poll4_x
    s_sleep 1
    s_cmp_gt_i32 s37, 0
    s_cbranch_scc1 L_b_poll4
    s_branch L_b_poll4_r
L_b_poll4_x:
    buffer_load_dwordx4 v[128:131], v253, s[16:19], s45 offen offset:0 sc1
    buffer_load_dwordx4 v[132:135], v253, s[16:19], s51 offen offset:0 sc1
    buffer_load_dwordx4 v[136:139], v253, s[16:19], s52 offen offset:0 sc1
    buffer_load_dwordx4 v[140:143], v253, s[16:19], s53 offen offset:0 sc1
    ds_read_b64_tr_b16 v[80:81], v224 offset:20480
    ds_read_b64_tr_b16 v[82:83], v224 offset:21504
    ds_read_b64_tr_b16 v[84:85], v226 offset:20480
    ds_read_b64_tr_b16 v[86:87], v226 offset:21504
    ds_read_b64_tr_b16 v[88:89], v224 offset:22528
    ds_read_b64_tr_b16 v[90:91], v224 offset:23552
    ds_read_b64_tr_b16 v[92:93], v226 offset:22528
    ds_read_b64_tr_b16 v[94:95], v226 offset:23552
    ds_read_b64_tr_b16 v[96:97], v224 offset:24576
    ds_read_b64_tr_b16 v[98:99], v224 offset:25600
    ds_read_b64_tr_b16 v[100:101], v226 offset:24576
    ds_read_b64_tr_b16 v[102:103], v226 offset:25600
    ds_read_b64_tr_b16 v[104:105], v224 offset:26624
    ds_read_b64_tr_b16 v[106:107], v224 offset:27648
    ds_read_b64_tr_b16 v[108:109], v226 offset:26624
    ds_read_b64_tr_b16 v[110:111], v226 offset:27648
    ds_read_b64_tr_b16 v[112:113], v224 offset:28672
    ds_read_b64_tr_b16 v[114:115], v224 offset:29696
    ds_read_b64_tr_b16 v[116:117], v226 offset:28672
    ds_read_b64_tr_b16 v[118:119], v226 offset:29696
    ds_read_b64_tr_b16 v[120:121], v224 offset:30720
    ds_read_b64_tr_b16 v[122:123], v224 offset:31744
    ds_read_b64_tr_b16 v[124:125], v226 offset:30720
    ds_read_b64_tr_b16 v[126:127], v226 offset:31744
    buffer_load_dwordx4 v[144:147], v253, s[16:19], s45 offen offset:128 sc1
    s_waitcnt vmcnt(4) lgkmcnt(0)
    v_mfma_f32_32x32x16_bf16 v[192:207], v[0:3], v[128:131], 0
    v_and_b32 v227, 31, v241
    v_mfma_f32_32x32x16_bf16 v[208:223], v[4:7], v[128:131], 0
    s_lshl1_add_u32 s33, s31, s30
    buffer_load_dwordx4 v[148:151], v253, s[16:19], s51 offen offset:128 sc1
    s_waitcnt vmcnt(4)
    v_mfma_f32_32x32x16_bf16 v[192:207], v[8:11], v[132:135], v[192:207]
    s_mul_i32 s33, s33, 8704
    v_mfma_f32_32x32x16_bf16 v[208:223], v[12:15], v[132:135], v[208:223]
    v_mul_u32_u24 v227, 272, v227
    buffer_load_dwordx4 v[152:155], v253, s[16:19], s52 offen offset:128 sc1
    s_waitcnt vmcnt(4)
    v_mfma_f32_32x32x16_bf16 v[192:207], v[16:19], v[136:139], v[192:207]
    v_lshl_add_u32 v227, v225, 6, v227
    v_mfma_f32_32x32x16_bf16 v[208:223], v[20:23], v[136:139], v[208:223]
    v_add_u32 v227, s33, v227
    buffer_load_dwordx4 v[156:159], v253, s[16:19], s53 offen offset:128 sc1
    s_waitcnt vmcnt(4)
    v_mfma_f32_32x32x16_bf16 v[192:207], v[24:27], v[140:143], v[192:207]
    v_lshrrev_b32 v230, 3, v241
    v_mfma_f32_32x32x16_bf16 v[208:223], v[28:31], v[140:143], v[208:223]
    s_lshl_b32 s33, s28, 4
    buffer_load_dwordx4 v[160:163], v253, s[16:19], s45 offen offset:256 sc1
    s_waitcnt vmcnt(4)
    v_mfma_f32_32x32x16_bf16 v[192:207], v[32:35], v[144:147], v[192:207]
    v_add_u32 v230, s33, v230
    v_mfma_f32_32x32x16_bf16 v[208:223], v[36:39], v[144:147], v[208:223]
    v_and_b32 v231, 7, v241
    buffer_load_dwordx4 v[164:167], v253, s[16:19], s51 offen offset:256 sc1
    s_waitcnt vmcnt(4)
    v_mfma_f32_32x32x16_bf16 v[192:207], v[40:43], v[148:151], v[192:207]
    v_mul_u32_u24 v228, 272, v230
    v_mfma_f32_32x32x16_bf16 v[208:223], v[44:47], v[148:151], v[208:223]
    v_lshl_add_u32 v228, v231, 5, v228
    buffer_load_dwordx4 v[168:171], v253, s[16:19], s52 offen offset:256 sc1
    s_waitcnt vmcnt(4)
    v_mfma_f32_32x32x16_bf16 v[192:207], v[48:51], v[152:155], v[192:207]
    v_lshlrev_b32 v229, 11, v230
    v_mfma_f32_32x32x16_bf16 v[208:223], v[52:55], v[152:155], v[208:223]
    v_lshl_add_u32 v229, v231, 4, v229
    buffer_load_dwordx4 v[172:175], v253, s[16:19], s53 offen offset:256 sc1
    s_waitcnt vmcnt(4)
    v_mfma_f32_32x32x16_bf16 v[192:207], v[56:59], v[156:159], v[192:207]
    s_lshl_b32 s32, s26, 17
    v_mfma_f32_32x32x16_bf16 v[208:223], v[60:63], v[156:159], v[208:223]
    s_lshl_b32 s33, s63, 7
    buffer_load_dwordx4 v[176:179], v253, s[16:19], s45 offen offset:384 sc1
    s_waitcnt vmcnt(4)
    v_mfma_f32_32x32x16_bf16 v[192:207], v[64:67], v[160:163], v[192:207]
    s_add_u32 s32, s32, s33
    v_mfma_f32_32x32x16_bf16 v[208:223], v[68:71], v[160:163], v[208:223]
    s_add_u32 s32, s32, 1024
    buffer_load_dwordx4 v[180:183], v253, s[16:19], s51 offen offset:384 sc1
    s_waitcnt vmcnt(4)
    v_mfma_f32_32x32x16_bf16 v[192:207], v[72:75], v[164:167], v[192:207]
    s_add_u32 s33, s32, 16384
    v_mfma_f32_32x32x16_bf16 v[208:223], v[76:79], v[164:167], v[208:223]
    s_add_u32 s50, s50, 69632
    buffer_load_dwordx4 v[184:187], v253, s[16:19], s52 offen offset:384 sc1
    s_waitcnt vmcnt(4)
    v_mfma_f32_32x32x16_bf16 v[192:207], v[80:83], v[168:171], v[192:207]
    v_add_u32 v249, 69632, v249
    v_mfma_f32_32x32x16_bf16 v[208:223], v[84:87], v[168:171], v[208:223]
    v_mov_b32 v252, s50
    buffer_load_dwordx4 v[188:191], v253, s[16:19], s53 offen offset:384 sc1
    s_waitcnt vmcnt(4)
    v_mfma_f32_32x32x16_bf16 v[192:207], v[88:91], v[172:175], v[192:207]
    s_lshl2_add_u32 s30, s26, 7340160
    v_mfma_f32_32x32x16_bf16 v[208:223], v[92:95], v[172:175], v[208:223]
    v_writelane_b32 v252, s30, 1
    s_waitcnt vmcnt(3)
    v_mfma_f32_32x32x16_bf16 v[192:207], v[96:99], v[176:179], v[192:207]
    v_mov_b32 v251, s46
    v_mfma_f32_32x32x16_bf16 v[208:223], v[100:103], v[176:179], v[208:223]
    v_writelane_b32 v251, s43, 1
    s_barrier
    s_waitcnt vmcnt(2)
    v_mfma_f32_32x32x16_bf16 v[192:207], v[104:107], v[180:183], v[192:207]
    v_mfma_f32_32x32x16_bf16 v[208:223], v[108:111], v[180:183], v[208:223]
    s_waitcnt vmcnt(1)
    v_mfma_f32_32x32x16_bf16 v[192:207], v[112:115], v[184:187], v[192:207]
    v_mfma_f32_32x32x16_bf16 v[208:223], v[116:119], v[184:187], v[208:223]
    s_waitcnt vmcnt(0)
    v_mfma_f32_32x32x16_bf16 v[192:207], v[120:123], v[188:191], v[192:207]
    v_mfma_f32_32x32x16_bf16 v[208:223], v[124:127], v[188:191], v[208:223]
    s_mov_b64 exec, 3
    buffer_store_dword v251, v252, s[20:23], 0 offen
    s_mov_b64 exec, -1
    s_nop 7
    ds_write_b128 v227, v[192:195] offset:0
    ds_write_b128 v227, v[196:199] offset:16
    ds_write_b128 v227, v[200:203] offset:32
    ds_write_b128 v227, v[204:207] offset:48
    ds_write_b128 v227, v[208:211] offset:128
    ds_write_b128 v227, v[212:215] offset:144
    ds_write_b128 v227, v[216:219] offset:160
    ds_write_b128 v227, v[220:223] offset:176
    s_waitcnt lgkmcnt(0)
    buffer_load_dword v232, v249, s[20:23], 0 offen sc1
    s_barrier
    ds_read_b128 v[0:3], v228 offset:0
    ds_read_b128 v[4:7], v228 offset:16
    ds_read_b128 v[8:11], v228 offset:17408
    ds_read_b128 v[12:15], v228 offset:17424
    ds_read_b128 v[16:19], v228 offset:2176
    ds_read_b128 v[20:23], v228 offset:2192
    ds_read_b128 v[24:27], v228 offset:19584
    ds_read_b128 v[28:31], v228 offset:19600
    s_waitcnt lgkmcnt(4)
    v_add_f32 v0, v0, v8
    v_add_f32 v1, v1, v9
    v_add_f32 v2, v2, v10
    v_add_f32 v3, v3, v11
    v_add_f32 v4, v4, v12
    v_add_f32 v5, v5, v13
    v_add_f32 v6, v6, v14
    v_add_f32 v7, v7, v15
    v_cvt_pk_bf16_f32 v32, v0, v1
    v_cvt_pk_bf16_f32 v33, v2, v3
    v_cvt_pk_bf16_f32 v34, v4, v5
    v_cvt_pk_bf16_f32 v35, v6, v7
    s_waitcnt lgkmcnt(0)
    v_add_f32 v16, v16, v24
    v_add_f32 v17, v17, v25
    v_add_f32 v18, v18, v26
    v_add_f32 v19, v19, v27
    v_add_f32 v20, v20, v28
    v_add_f32 v21, v21, v29
    v_add_f32 v22, v22, v30
    v_add_f32 v23, v23, v31
    v_cvt_pk_bf16_f32 v36, v16, v17
    v_cvt_pk_bf16_f32 v37, v18, v19
    v_cvt_pk_bf16_f32 v38, v20, v21
    v_cvt_pk_bf16_f32 v39, v22, v23
    s_waitcnt vmcnt(0)
    v_cmp_ne_u32 vcc, s46, v232
    s_nop 0
    s_cmp_eq_u64 vcc, 0
    s_cbranch_scc1 L_b_poll6_x
    s_mov_b32 s37, s47
L_b_poll6:
    buffer_load_dword v232, v249, s[20:23], 0 offen sc1
    s_waitcnt vmcnt(0)
    v_cmp_ne_u32 vcc, s46, v232
    s_sub_u32 s37, s37, 1
    s_cmp_lg_u64 vcc, 0
    s_cbranch_scc0 L_b_poll6_x
    s_cmp_gt_i32 s37, 0
    s_cbranch_scc1 L_b_poll6
    s_branch L_b_poll6_r
L_b_poll6_x:
    buffer_store_dwordx4 v[32:35], v229, s[16:19], s32 offen
    buffer_store_dwordx4 v[36:39], v229, s[16:19], s33 offen
    s_endpgm
L_A1:
    s_load_dwordx2 s[12:13], s[0:1], 0
    s_load_dwordx2 s[20:21], s[0:1], 72
    s_load_dwordx2 s[24:25], s[0:1], 88
    s_load_dwordx2 s[30:31], s[0:1], 40
    s_mov_b32 s14, 2097152
    s_mov_b32 s15, 0x20000
    s_mov_b32 s22, 4194304
    s_mov_b32 s23, 0x20000
    s_mov_b32 s26, 16777216
    s_mov_b32 s27, 0x20000
    v_and_b32 v1, 63, v0
    v_lshrrev_b32 v7, 2, v6
    s_add_u32 s35, s35, 7344128
    v_lshl_add_u32 v99, v1, 3, s35
    s_lshl2_add_u32 s46, s33, s34
    s_lshl2_add_u32 s46, s46, s35
    v_and_b32 v8, 15, v0
    v_lshl_add_u32 v8, v2, 4, v8
    s_lshl_b32 s35, s33, 17
    s_add_u32 s35, s35, s36
    v_lshl_add_u32 v27, v8, 11, s35
    v_mov_b32 v10, 0
    v_lshrrev_b32 v8, 7, v0
    v_and_b32 v9, 127, v0
    v_mul_u32_u24 v8, 4608, v8
    v_lshl_add_u32 v8, v9, 2, v8
    ds_write_b32 v8, v10 offset:25600
    v_lshrrev_b32 v8, 3, v1
    v_mul_u32_u24 v8, 4160, v8
    v_lshl_add_u32 v8, v4, 2, v8
    ds_write_b32 v8, v10 offset:34824
    v_lshrrev_b32 v8, 2, v3
    v_and_b32 v9, 3, v3
    v_lshlrev_b32 v9, 2, v9
    v_lshl_add_u32 v9, v4, 10, v9
    v_xor_b32 v11, v8, v4
    v_lshl_add_u32 v44, v11, 4, v9
    v_add_u32 v11, 1, v4
    v_and_b32 v11, 7, v11
    v_xor_b32 v11, v8, v11
    v_lshl_add_u32 v45, v11, 4, v9
    v_lshl_add_u32 v11, v4, 4, s36
    s_lshl_b32 s35, s33, 17
    v_lshl_add_u32 v46, v3, 12, v11
    v_add_u32 v46, s35, v46
    s_lshl_b32 s35, s33, 12
    v_lshl_add_u32 v47, v3, 17, v11
    v_add_u32 v47, s35, v47
    s_lshr_b32 s36, s34, 1
    s_and_b32 s37, s34, 1
    v_and_b32 v4, 3, v0
    v_mul_u32_u24 v16, 4160, v4
    v_lshrrev_b32 v5, 4, v1
    v_lshl_add_u32 v16, v5, 4, v16
    v_and_b32 v4, 12, v0
    v_lshl_add_u32 v16, v4, 1, v16
    s_mul_i32 s38, s36, 16640
    s_lshl_b32 s37, s37, 8
    s_add_u32 s38, s38, s37
    s_add_u32 s38, s38, 34824
    v_add_u32 v16, s38, v16
    v_and_b32 v8, 15, v0
    v_lshlrev_b32 v17, 1, v8
    v_sub_u32 v17, v17, v5
    v_lshlrev_b32 v17, 4, v17
    s_mul_i32 s38, s36, 4608
    s_sub_u32 s38, s38, s37
    s_add_u32 s38, s38, 25936
    v_add_u32 v17, s38, v17
    v_bfe_u32 v4, v0, 1, 2
    v_xor_b32 v4, v4, v5
    v_lshlrev_b32 v4, 4, v4
    v_lshl_add_u32 v98, v8, 6, v4
    s_lshl_b32 s38, s34, 13
    s_add_u32 s38, s38, 34816
    v_add_u32 v98, s38, v98
    s_getreg_b32 s44, hwreg(HW_REG_XCC_ID, 0, 4)
    s_mov_b32 s45, 96
    s_lshl2_add_u32 s35, s32, 7340032
    s_waitcnt lgkmcnt(0)
    s_load_dword s39, s[24:25], s35
    s_or_b32 s35, s33, s34
    s_cbranch_scc0 L_a_touch
L_a_touch_x:
    s_setprio 1
    s_waitcnt vmcnt(4)
    v_lshlrev_b32 v68, 16, v20
    v_lshlrev_b32 v69, 16, v22
    v_and_b32 v70, 0xffff0000, v20
    v_and_b32 v71, 0xffff0000, v22
    v_lshlrev_b32 v72, 16, v21
    v_lshlrev_b32 v73, 16, v23
    v_and_b32 v74, 0xffff0000, v21
    v_and_b32 v75, 0xffff0000, v23
    s_barrier
    ds_read_b32 v48, v44 offset:640
    ds_read_b32 v49, v44 offset:768
    ds_read_b32 v50, v44 offset:896
    ds_read_b32 v51, v45 offset:1024
    ds_read_b32 v52, v45 offset:1152
    ds_read_b32 v53, v45 offset:1280
    ds_read_b32 v54, v45 offset:1408
    ds_read_b32 v55, v45 offset:1536
    ds_read_b32 v56, v45 offset:1664
    ds_read_b32 v57, v45 offset:1792
    ds_read_b32 v58, v45 offset:1920
    ds_read_b32 v60, v44 offset:9216
    ds_read_b32 v61, v44 offset:9344
    ds_read_b32 v62, v44 offset:9472
    ds_read_b32 v63, v44 offset:9600
    ds_read_b32 v64, v44 offset:9728
    ds_read_b32 v65, v44 offset:9856
    ds_read_b32 v66, v44 offset:9984
    ds_read_b32 v67, v44 offset:10112
    s_waitcnt lgkmcnt(8)
    v_lshlrev_b32 v136, 16, v48
    v_and_b32 v137, 0xffff0000, v48
    v_lshlrev_b32 v138, 16, v49
    v_and_b32 v139, 0xffff0000, v49
    v_lshlrev_b32 v140, 16, v50
    v_and_b32 v141, 0xffff0000, v50
    v_lshlrev_b32 v142, 16, v51
    v_and_b32 v143, 0xffff0000, v51
    v_lshlrev_b32 v144, 16, v52
    v_and_b32 v145, 0xffff0000, v52
    v_lshlrev_b32 v146, 16, v53
    v_and_b32 v147, 0xffff0000, v53
    v_lshlrev_b32 v148, 16, v54
    v_and_b32 v149, 0xffff0000, v54
    v_lshlrev_b32 v150, 16, v55
    v_and_b32 v151, 0xffff0000, v55
    v_lshlrev_b32 v152, 16, v56
    v_and_b32 v153, 0xffff0000, v56
    v_lshlrev_b32 v154, 16, v57
    v_and_b32 v155, 0xffff0000, v57
    v_lshlrev_b32 v156, 16, v58
    v_and_b32 v157, 0xffff0000, v58
    v_mul_f32 v116, v142, v68
    v_mul_f32 v117, v143, v69
    v_mul_f32 v118, v144, v68
    v_mul_f32 v119, v145, v69
    v_mul_f32 v120, v146, v68
    v_mul_f32 v121, v147, v69
    v_mul_f32 v122, v148, v68
    v_mul_f32 v123, v149, v69
    v_mul_f32 v124, v150, v68
    v_mul_f32 v125, v151, v69
    v_mul_f32 v126, v152, v68
    v_mul_f32 v127, v153, v69
    v_mul_f32 v128, v154, v68
    v_mul_f32 v129, v155, v69
    v_mul_f32 v130, v156, v68
    v_mul_f32 v131, v157, v69
    v_fmac_f32 v116, v140, v70
    v_fmac_f32 v117, v141, v71
    v_fmac_f32 v118, v142, v70
    v_fmac_f32 v119, v143, v71
    v_fmac_f32 v120, v144, v70
    v_fmac_f32 v121, v145, v71
    v_fmac_f32 v122, v146, v70
    v_fmac_f32 v123, v147, v71
    v_fmac_f32 v124, v148, v70
    v_fmac_f32 v125, v149, v71
    v_fmac_f32 v126, v150, v70
    v_fmac_f32 v127, v151, v71
    v_fmac_f32 v128, v152, v70
    v_fmac_f32 v129, v153, v71
    v_fmac_f32 v130, v154, v70
    v_fmac_f32 v131, v155, v71
    v_fmac_f32 v116, v138, v72
    v_fmac_f32 v117, v139, v73
    v_fmac_f32 v118, v140, v72
    v_fmac_f32 v119, v141, v73
    v_fmac_f32 v120, v142, v72
    v_fmac_f32 v121, v143, v73
    v_fmac_f32 v122, v144, v72
    v_fmac_f32 v123, v145, v73
    v_fmac_f32 v124, v146, v72
    v_fmac_f32 v125, v147, v73
    v_fmac_f32 v126, v148, v72
    v_fmac_f32 v127, v149, v73
    v_fmac_f32 v128, v150, v72
    v_fmac_f32 v129, v151, v73
    v_fmac_f32 v130, v152, v72
    v_fmac_f32 v131, v153, v73
    v_fmac_f32 v116, v136, v74
    v_fmac_f32 v117, v137, v75
    v_fmac_f32 v118, v138, v74
    v_fmac_f32 v119, v139, v75
    v_fmac_f32 v120, v140, v74
    v_fmac_f32 v121, v141, v75
    v_fmac_f32 v122, v142, v74
    v_fmac_f32 v123, v143, v75
    v_fmac_f32 v124, v144, v74
    v_fmac_f32 v125, v145, v75
    v_fmac_f32 v126, v146, v74
    v_fmac_f32 v127, v147, v75
    v_fmac_f32 v128, v148, v74
    v_fmac_f32 v129, v149, v75
    v_fmac_f32 v130, v150, v74
    v_fmac_f32 v131, v151, v75
    s_waitcnt lgkmcnt(0)
    v_lshlrev_b32 v100, 16, v60
    v_and_b32 v101, 0xffff0000, v60
    v_lshlrev_b32 v102, 16, v61
    v_and_b32 v103, 0xffff0000, v61
    v_lshlrev_b32 v104, 16, v62
    v_and_b32 v105, 0xffff0000, v62
    v_lshlrev_b32 v106, 16, v63
    v_and_b32 v107, 0xffff0000, v63
    v_lshlrev_b32 v108, 16, v64
    v_and_b32 v109, 0xffff0000, v64
    v_lshlrev_b32 v110, 16, v65
    v_and_b32 v111, 0xffff0000, v65
    v_lshlrev_b32 v112, 16, v66
    v_and_b32 v113, 0xffff0000, v66
    v_lshlrev_b32 v114, 16, v67
    v_and_b32 v115, 0xffff0000, v67
    v_mul_f32 v116, v116, v100
    v_mul_f32 v118, v118, v102
    v_mul_f32 v120, v120, v104
    v_mul_f32 v122, v122, v106
    v_mul_f32 v124, v124, v108
    v_mul_f32 v126, v126, v110
    v_mul_f32 v128, v128, v112
    v_mul_f32 v130, v130, v114
    v_cvt_pk_bf16_f32 v160, v130, v128
    v_cvt_pk_bf16_f32 v161, v126, v124
    v_cvt_pk_bf16_f32 v162, v122, v120
    v_cvt_pk_bf16_f32 v163, v118, v116
    buffer_store_dwordx4 v[160:163], v46, s[20:23], 0 offen offset:0 sc1
    v_mul_f32 v117, v117, v101
    v_mul_f32 v119, v119, v103
    v_mul_f32 v121, v121, v105
    v_mul_f32 v123, v123, v107
    v_mul_f32 v125, v125, v109
    v_mul_f32 v127, v127, v111
    v_mul_f32 v129, v129, v113
    v_mul_f32 v131, v131, v115
    v_cvt_pk_bf16_f32 v164, v131, v129
    v_cvt_pk_bf16_f32 v165, v127, v125
    v_cvt_pk_bf16_f32 v166, v123, v121
    v_cvt_pk_bf16_f32 v167, v119, v117
    buffer_store_dwordx4 v[164:167], v46, s[20:23], 0 offen offset:2048 sc1
    s_add_u32 s40, s39, 0x9e377900
    s_and_b32 s40, s40, 0xffffff00
    s_or_b32 s44, s44, s40
    v_cmp_ne_u32 vcc, 0, v0
    v_lshlrev_b32 v2, 4, v0
    v_mov_b32 v10, s46
    v_mov_b32 v11, s44
    s_waitcnt vmcnt(2)
    v_cndmask_b32 v28, 0, v28, vcc
    v_cndmask_b32 v29, 0, v29, vcc
    v_alignbit_b32 v168, v29, v28, 16
    v_alignbit_b32 v169, v30, v29, 16
    v_alignbit_b32 v170, v31, v30, 16
    v_alignbit_b32 v171, v32, v31, 16
    v_mov_b32 v172, v29
    v_mov_b32 v173, v30
    v_mov_b32 v174, v31
    v_mov_b32 v175, v32
    v_alignbit_b32 v176, v30, v29, 16
    v_alignbit_b32 v177, v31, v30, 16
    v_alignbit_b32 v178, v32, v31, 16
    v_alignbit_b32 v179, v33, v32, 16
    v_cndmask_b32 v36, 0, v36, vcc
    v_cndmask_b32 v37, 0, v37, vcc
    v_alignbit_b32 v180, v37, v36, 16
    v_alignbit_b32 v181, v38, v37, 16
    v_alignbit_b32 v182, v39, v38, 16
    v_alignbit_b32 v183, v40, v39, 16
    v_mov_b32 v184, v37
    v_mov_b32 v185, v38
    v_mov_b32 v186, v39
    v_mov_b32 v187, v40
    v_alignbit_b32 v188, v38, v37, 16
    v_alignbit_b32 v189, v39, v38, 16
    v_alignbit_b32 v190, v40, v39, 16
    v_alignbit_b32 v191, v41, v40, 16
    ds_write_b128 v2, v[168:171] offset:34848
    ds_write_b128 v2, v[172:175] offset:39008
    ds_write_b128 v2, v[176:179] offset:43168
    ds_write_b128 v2, v[30:33] offset:47328
    ds_write_b128 v2, v[180:183] offset:51488
    ds_write_b128 v2, v[184:187] offset:55648
    ds_write_b128 v2, v[188:191] offset:59808
    ds_write_b128 v2, v[38:41] offset:63968
    s_waitcnt vmcnt(0)
    s_mov_b64 exec, 1
    buffer_store_dword v11, v10, s[24:27], 0 offen
    s_mov_b64 exec, -1
    global_load_dword v24, v7, s[30:31]
    s_mov_b32 s41, s45
L_a_poll1:
    buffer_load_dwordx2 v[12:13], v99, s[24:27], 0 offen sc1
    s_waitcnt vmcnt(0)
    v_cmp_ne_u32 vcc, s44, v12
    v_cmp_ne_u32 s[42:43], s44, v13
    s_sub_u32 s41, s41, 1
    s_or_b64 vcc, vcc, s[42:43]
    s_cbranch_scc0 L_a_poll1_x
    s_sleep 8
    s_cmp_gt_i32 s41, 0
    s_cbranch_scc1 L_a_poll1
    s_branch L_a_poll1_r
L_a_poll1_x:
    v_mov_b32 v11, s44
    buffer_load_dwordx4 v[56:59], v47, s[20:23], 0 offen offset:0 sc1
    buffer_load_dwordx4 v[60:63], v47, s[20:23], 0 offen offset:2048 sc1
    v_lshlrev_b32 v76, 16, v24
    v_and_b32 v77, 0xffff0000, v24
    v_mul_f32 v116, v116, v76
    v_mul_f32 v117, v117, v77
    v_mul_f32 v118, v118, v76
    v_mul_f32 v119, v119, v77
    v_mul_f32 v120, v120, v76
    v_mul_f32 v121, v121, v77
    v_mul_f32 v122, v122, v76
    v_mul_f32 v123, v123, v77
    v_mul_f32 v124, v124, v76
    v_mul_f32 v125, v125, v77
    v_mul_f32 v126, v126, v76
    v_mul_f32 v127, v127, v77
    v_mul_f32 v128, v128, v76
    v_mul_f32 v129, v129, v77
    v_mul_f32 v130, v130, v76
    v_mul_f32 v131, v131, v77
    v_add_u32 v99, 4096, v99
    s_addk_i32 s46, 4096
    v_add_u32 v10, 4096, v10
    s_waitcnt vmcnt(1)
    ds_write_b128 v2, v[56:59] offset:26112
    s_waitcnt vmcnt(0)
    ds_write_b128 v2, v[60:63] offset:30720
    s_waitcnt lgkmcnt(0)
    s_barrier
    s_setprio 0
    ds_read_b64 v[136:137], v16 offset:0
    ds_read_b64 v[138:139], v16 offset:8
    ds_read_b128 v[168:171], v17 offset:192
    ds_read_b128 v[172:175], v17 offset:704
    ds_read_b128 v[176:179], v17 offset:1216
    ds_read_b128 v[180:183], v17 offset:1728
    ds_read_b128 v[184:187], v17 offset:2240
    ds_read_b128 v[188:191], v17 offset:2752
    ds_read_b128 v[192:195], v17 offset:3264
    ds_read_b128 v[196:199], v17 offset:3776
    ds_read_b64 v[140:141], v16 offset:512
    ds_read_b64 v[142:143], v16 offset:520
    s_waitcnt lgkmcnt(9)
    v_mfma_f32_16x16x32_bf16 v[56:59], v[136:139], v[168:171], 0
    ds_read_b64 v[144:145], v16 offset:1024
    ds_read_b64 v[146:147], v16 offset:1032
    s_waitcnt lgkmcnt(10)
    v_mfma_f32_16x16x32_bf16 v[60:63], v[136:139], v[172:175], 0
    ds_read_b64 v[148:149], v16 offset:1536
    ds_read_b64 v[150:151], v16 offset:1544
    s_waitcnt lgkmcnt(11)
    v_mfma_f32_16x16x32_bf16 v[64:67], v[136:139], v[176:179], 0
    ds_read_b64 v[152:153], v16 offset:2048
    ds_read_b64 v[154:155], v16 offset:2056
    s_waitcnt lgkmcnt(12)
    v_mfma_f32_16x16x32_bf16 v[68:71], v[136:139], v[180:183], 0
    ds_read_b64 v[156:157], v16 offset:2560
    ds_read_b64 v[158:159], v16 offset:2568
    s_waitcnt lgkmcnt(13)
    v_mfma_f32_16x16x32_bf16 v[72:75], v[136:139], v[184:187], 0
    ds_read_b64 v[160:161], v16 offset:3072
    ds_read_b64 v[162:163], v16 offset:3080
    s_waitcnt lgkmcnt(14)
    v_mfma_f32_16x16x32_bf16 v[76:79], v[136:139], v[188:191], 0
    ds_read_b64 v[164:165], v16 offset:3584
    ds_read_b64 v[166:167], v16 offset:3592
    s_waitcnt lgkmcnt(15)
    v_mfma_f32_16x16x32_bf16 v[80:83], v[136:139], v[192:195], 0
    s_waitcnt lgkmcnt(14)
    v_mfma_f32_16x16x32_bf16 v[84:87], v[136:139], v[196:199], 0
    s_waitcnt lgkmcnt(0)
    v_mfma_f32_16x16x32_bf16 v[60:63], v[140:143], v[168:171], v[60:63]
    ds_read_b64 v[200:201], v16 offset:64
    v_mfma_f32_16x16x32_bf16 v[64:67], v[140:143], v[172:175], v[64:67]
    ds_read_b64 v[202:203], v16 offset:72
    v_mfma_f32_16x16x32_bf16 v[68:71], v[140:143], v[176:179], v[68:71]
    ds_read_b128 v[232:235], v17 offset:128
    v_mfma_f32_16x16x32_bf16 v[72:75], v[140:143], v[180:183], v[72:75]
    ds_read_b64 v[204:205], v16 offset:576
    v_mfma_f32_16x16x32_bf16 v[76:79], v[140:143], v[184:187], v[76:79]
    ds_read_b64 v[206:207], v16 offset:584
    v_mfma_f32_16x16x32_bf16 v[80:83], v[140:143], v[188:191], v[80:83]
    ds_read_b128 v[236:239], v17 offset:640
    v_mfma_f32_16x16x32_bf16 v[84:87], v[140:143], v[192:195], v[84:87]
    ds_read_b64 v[208:209], v16 offset:1088
    v_mfma_f32_16x16x32_bf16 v[64:67], v[144:147], v[168:171], v[64:67]
    ds_read_b64 v[210:211], v16 offset:1096
    v_mfma_f32_16x16x32_bf16 v[68:71], v[144:147], v[172:175], v[68:71]
    ds_read_b128 v[240:243], v17 offset:1152
    v_mfma_f32_16x16x32_bf16 v[72:75], v[144:147], v[176:179], v[72:75]
    ds_read_b64 v[212:213], v16 offset:1600
    v_mfma_f32_16x16x32_bf16 v[76:79], v[144:147], v[180:183], v[76:79]
    ds_read_b64 v[214:215], v16 offset:1608
    v_mfma_f32_16x16x32_bf16 v[80:83], v[144:147], v[184:187], v[80:83]
    ds_read_b128 v[244:247], v17 offset:1664
    v_mfma_f32_16x16x32_bf16 v[84:87], v[144:147], v[188:191], v[84:87]
    ds_read_b64 v[216:217], v16 offset:2112
    v_mfma_f32_16x16x32_bf16 v[68:71], v[148:151], v[168:171], v[68:71]
    ds_read_b64 v[218:219], v16 offset:2120
    v_mfma_f32_16x16x32_bf16 v[72:75], v[148:151], v[172:175], v[72:75]
    ds_read_b128 v[248:251], v17 offset:2176
    v_mfma_f32_16x16x32_bf16 v[76:79], v[148:151], v[176:179], v[76:79]
    ds_read_b64 v[220:221], v16 offset:2624
    v_mfma_f32_16x16x32_bf16 v[80:83], v[148:151], v[180:183], v[80:83]
    ds_read_b64 v[222:223], v16 offset:2632
    v_mfma_f32_16x16x32_bf16 v[84:87], v[148:151], v[184:187], v[84:87]
    ds_read_b128 v[252:255], v17 offset:2688
    v_mfma_f32_16x16x32_bf16 v[72:75], v[152:155], v[168:171], v[72:75]
    ds_read_b64 v[224:225], v16 offset:3136
    v_mfma_f32_16x16x32_bf16 v[76:79], v[152:155], v[172:175], v[76:79]
    ds_read_b64 v[226:227], v16 offset:3144
    v_mfma_f32_16x16x32_bf16 v[80:83], v[152:155], v[176:179], v[80:83]
    ds_read_b128 v[88:91], v17 offset:3200
    v_mfma_f32_16x16x32_bf16 v[84:87], v[152:155], v[180:183], v[84:87]
    ds_read_b64 v[228:229], v16 offset:3648
    v_mfma_f32_16x16x32_bf16 v[76:79], v[156:159], v[168:171], v[76:79]
    ds_read_b64 v[230:231], v16 offset:3656
    v_mfma_f32_16x16x32_bf16 v[80:83], v[156:159], v[172:175], v[80:83]
    ds_read_b128 v[92:95], v17 offset:3712
    v_mfma_f32_16x16x32_bf16 v[84:87], v[156:159], v[176:179], v[84:87]
    v_mfma_f32_16x16x32_bf16 v[80:83], v[160:163], v[168:171], v[80:83]
    v_mfma_f32_16x16x32_bf16 v[84:87], v[160:163], v[172:175], v[84:87]
    v_mfma_f32_16x16x32_bf16 v[84:87], v[164:167], v[168:171], v[84:87]
    s_waitcnt lgkmcnt(0)
    v_mfma_f32_16x16x32_bf16 v[56:59], v[200:203], v[232:235], v[56:59]
    ds_read_b64 v[136:137], v16 offset:128
    v_mfma_f32_16x16x32_bf16 v[60:63], v[200:203], v[236:239], v[60:63]
    ds_read_b64 v[138:139], v16 offset:136
    v_mfma_f32_16x16x32_bf16 v[64:67], v[200:203], v[240:243], v[64:67]
    ds_read_b128 v[168:171], v17 offset:64
    v_mfma_f32_16x16x32_bf16 v[68:71], v[200:203], v[244:247], v[68:71]
    ds_read_b64 v[140:141], v16 offset:640
    v_mfma_f32_16x16x32_bf16 v[72:75], v[200:203], v[248:251], v[72:75]
    ds_read_b64 v[142:143], v16 offset:648
    v_mfma_f32_16x16x32_bf16 v[76:79], v[200:203], v[252:255], v[76:79]
    ds_read_b128 v[172:175], v17 offset:576
    v_mfma_f32_16x16x32_bf16 v[80:83], v[200:203], v[88:91], v[80:83]
    ds_read_b64 v[144:145], v16 offset:1152
    v_mfma_f32_16x16x32_bf16 v[84:87], v[200:203], v[92:95], v[84:87]
    ds_read_b64 v[146:147], v16 offset:1160
    v_mfma_f32_16x16x32_bf16 v[60:63], v[204:207], v[232:235], v[60:63]
    ds_read_b128 v[176:179], v17 offset:1088
    v_mfma_f32_16x16x32_bf16 v[64:67], v[204:207], v[236:239], v[64:67]
    ds_read_b64 v[148:149], v16 offset:1664
    v_mfma_f32_16x16x32_bf16 v[68:71], v[204:207], v[240:243], v[68:71]
    ds_read_b64 v[150:151], v16 offset:1672
    v_mfma_f32_16x16x32_bf16 v[72:75], v[204:207], v[244:247], v[72:75]
    ds_read_b128 v[180:183], v17 offset:1600
    v_mfma_f32_16x16x32_bf16 v[76:79], v[204:207], v[248:251], v[76:79]
    ds_read_b64 v[152:153], v16 offset:2176
    v_mfma_f32_16x16x32_bf16 v[80:83], v[204:207], v[252:255], v[80:83]
    ds_read_b64 v[154:155], v16 offset:2184
    v_mfma_f32_16x16x32_bf16 v[84:87], v[204:207], v[88:91], v[84:87]
    ds_read_b128 v[184:187], v17 offset:2112
    v_mfma_f32_16x16x32_bf16 v[64:67], v[208:211], v[232:235], v[64:67]
    ds_read_b64 v[156:157], v16 offset:2688
    v_mfma_f32_16x16x32_bf16 v[68:71], v[208:211], v[236:239], v[68:71]
    ds_read_b64 v[158:159], v16 offset:2696
    v_mfma_f32_16x16x32_bf16 v[72:75], v[208:211], v[240:243], v[72:75]
    ds_read_b128 v[188:191], v17 offset:2624
    v_mfma_f32_16x16x32_bf16 v[76:79], v[208:211], v[244:247], v[76:79]
    ds_read_b64 v[160:161], v16 offset:3200
    v_mfma_f32_16x16x32_bf16 v[80:83], v[208:211], v[248:251], v[80:83]
    ds_read_b64 v[162:163], v16 offset:3208
    v_mfma_f32_16x16x32_bf16 v[84:87], v[208:211], v[252:255], v[84:87]
    ds_read_b128 v[192:195], v17 offset:3136
    v_mfma_f32_16x16x32_bf16 v[68:71], v[212:215], v[232:235], v[68:71]
    ds_read_b64 v[164:165], v16 offset:3712
    v_mfma_f32_16x16x32_bf16 v[72:75], v[212:215], v[236:239], v[72:75]
    ds_read_b64 v[166:167], v16 offset:3720
    v_mfma_f32_16x16x32_bf16 v[76:79], v[212:215], v[240:243], v[76:79]
    ds_read_b128 v[196:199], v17 offset:3648
    v_mfma_f32_16x16x32_bf16 v[80:83], v[212:215], v[244:247], v[80:83]
    v_mfma_f32_16x16x32_bf16 v[84:87], v[212:215], v[248:251], v[84:87]
    v_mfma_f32_16x16x32_bf16 v[72:75], v[216:219], v[232:235], v[72:75]
    v_mfma_f32_16x16x32_bf16 v[76:79], v[216:219], v[236:239], v[76:79]
    v_mfma_f32_16x16x32_bf16 v[80:83], v[216:219], v[240:243], v[80:83]
    v_mfma_f32_16x16x32_bf16 v[84:87], v[216:219], v[244:247], v[84:87]
    v_mfma_f32_16x16x32_bf16 v[76:79], v[220:223], v[232:235], v[76:79]
    v_mfma_f32_16x16x32_bf16 v[80:83], v[220:223], v[236:239], v[80:83]
    v_mfma_f32_16x16x32_bf16 v[84:87], v[220:223], v[240:243], v[84:87]
    v_mfma_f32_16x16x32_bf16 v[80:83], v[224:227], v[232:235], v[80:83]
    v_mfma_f32_16x16x32_bf16 v[84:87], v[224:227], v[236:239], v[84:87]
    v_mfma_f32_16x16x32_bf16 v[84:87], v[228:231], v[232:235], v[84:87]
    s_add_u32 m0, s48, 17408
    s_nop 0
    buffer_load_dwordx4 v96, s[12:15], 0 offen lds
    s_add_u32 m0, s48, 21504
    s_nop 0
    buffer_load_dwordx4 v97, s[12:15], 0 offen lds
    s_waitcnt lgkmcnt(0)
    v_mfma_f32_16x16x32_bf16 v[56:59], v[136:139], v[168:171], v[56:59]
    ds_read_b64 v[200:201], v16 offset:192
    v_mfma_f32_16x16x32_bf16 v[60:63], v[136:139], v[172:175], v[60:63]
    ds_read_b64 v[202:203], v16 offset:200
    v_mfma_f32_16x16x32_bf16 v[64:67], v[136:139], v[176:179], v[64:67]
    ds_read_b128 v[232:235], v17 offset:0
    v_mfma_f32_16x16x32_bf16 v[68:71], v[136:139], v[180:183], v[68:71]
    ds_read_b64 v[204:205], v16 offset:704
    v_mfma_f32_16x16x32_bf16 v[72:75], v[136:139], v[184:187], v[72:75]
    ds_read_b64 v[206:207], v16 offset:712
    v_mfma_f32_16x16x32_bf16 v[76:79], v[136:139], v[188:191], v[76:79]
    ds_read_b128 v[236:239], v17 offset:512
    v_mfma_f32_16x16x32_bf16 v[80:83], v[136:139], v[192:195], v[80:83]
    ds_read_b64 v[208:209], v16 offset:1216
    v_mfma_f32_16x16x32_bf16 v[84:87], v[136:139], v[196:199], v[84:87]
    ds_read_b64 v[210:211], v16 offset:1224
    v_mfma_f32_16x16x32_bf16 v[60:63], v[140:143], v[168:171], v[60:63]
    ds_read_b128 v[240:243], v17 offset:1024
    v_mfma_f32_16x16x32_bf16 v[64:67], v[140:143], v[172:175], v[64:67]
    ds_read_b64 v[212:213], v16 offset:1728
    v_mfma_f32_16x16x32_bf16 v[68:71], v[140:143], v[176:179], v[68:71]
    ds_read_b64 v[214:215], v16 offset:1736
    v_mfma_f32_16x16x32_bf16 v[72:75], v[140:143], v[180:183], v[72:75]
    ds_read_b128 v[244:247], v17 offset:1536
    v_mfma_f32_16x16x32_bf16 v[76:79], v[140:143], v[184:187], v[76:79]
    ds_read_b64 v[216:217], v16 offset:2240
    v_mfma_f32_16x16x32_bf16 v[80:83], v[140:143], v[188:191], v[80:83]
    ds_read_b64 v[218:219], v16 offset:2248
    v_mfma_f32_16x16x32_bf16 v[84:87], v[140:143], v[192:195], v[84:87]
    ds_read_b128 v[248:251], v17 offset:2048
    v_mfma_f32_16x16x32_bf16 v[64:67], v[144:147], v[168:171], v[64:67]
    ds_read_b64 v[220:221], v16 offset:2752
    v_mfma_f32_16x16x32_bf16 v[68:71], v[144:147], v[172:175], v[68:71]
    ds_read_b64 v[222:223], v16 offset:2760
    v_mfma_f32_16x16x32_bf16 v[72:75], v[144:147], v[176:179], v[72:75]
    ds_read_b128 v[252:255], v17 offset:2560
    v_mfma_f32_16x16x32_bf16 v[76:79], v[144:147], v[180:183], v[76:79]
    ds_read_b64 v[224:225], v16 offset:3264
    v_mfma_f32_16x16x32_bf16 v[80:83], v[144:147], v[184:187], v[80:83]
    ds_read_b64 v[226:227], v16 offset:3272
    v_mfma_f32_16x16x32_bf16 v[84:87], v[144:147], v[188:191], v[84:87]
    ds_read_b128 v[88:91], v17 offset:3072
    v_mfma_f32_16x16x32_bf16 v[68:71], v[148:151], v[168:171], v[68:71]
    ds_read_b64 v[228:229], v16 offset:3776
    v_mfma_f32_16x16x32_bf16 v[72:75], v[148:151], v[172:175], v[72:75]
    ds_read_b64 v[230:231], v16 offset:3784
    v_mfma_f32_16x16x32_bf16 v[76:79], v[148:151], v[176:179], v[76:79]
    ds_read_b128 v[92:95], v17 offset:3584
    v_mfma_f32_16x16x32_bf16 v[80:83], v[148:151], v[180:183], v[80:83]
    v_mfma_f32_16x16x32_bf16 v[84:87], v[148:151], v[184:187], v[84:87]
    v_mfma_f32_16x16x32_bf16 v[72:75], v[152:155], v[168:171], v[72:75]
    v_mfma_f32_16x16x32_bf16 v[76:79], v[152:155], v[172:175], v[76:79]
    v_mfma_f32_16x16x32_bf16 v[80:83], v[152:155], v[176:179], v[80:83]
    v_mfma_f32_16x16x32_bf16 v[84:87], v[152:155], v[180:183], v[84:87]
    v_mfma_f32_16x16x32_bf16 v[76:79], v[156:159], v[168:171], v[76:79]
    v_mfma_f32_16x16x32_bf16 v[80:83], v[156:159], v[172:175], v[80:83]
    v_mfma_f32_16x16x32_bf16 v[84:87], v[156:159], v[176:179], v[84:87]
    v_mfma_f32_16x16x32_bf16 v[80:83], v[160:163], v[168:171], v[80:83]
    v_mfma_f32_16x16x32_bf16 v[84:87], v[160:163], v[172:175], v[84:87]
    v_mfma_f32_16x16x32_bf16 v[84:87], v[164:167], v[168:171], v[84:87]
    s_waitcnt lgkmcnt(0)
    v_mfma_f32_16x16x32_bf16 v[56:59], v[200:203], v[232:235], v[56:59]
    v_mfma_f32_16x16x32_bf16 v[60:63], v[200:203], v[236:239], v[60:63]
    v_mfma_f32_16x16x32_bf16 v[64:67], v[200:203], v[240:243], v[64:67]
    v_mfma_f32_16x16x32_bf16 v[68:71], v[200:203], v[244:247], v[68:71]
    v_mfma_f32_16x16x32_bf16 v[72:75], v[200:203], v[248:251], v[72:75]
    v_mfma_f32_16x16x32_bf16 v[76:79], v[200:203], v[252:255], v[76:79]
    v_mfma_f32_16x16x32_bf16 v[80:83], v[200:203], v[88:91], v[80:83]
    v_mfma_f32_16x16x32_bf16 v[84:87], v[200:203], v[92:95], v[84:87]
    v_mfma_f32_16x16x32_bf16 v[60:63], v[204:207], v[232:235], v[60:63]
    v_mfma_f32_16x16x32_bf16 v[64:67], v[204:207], v[236:239], v[64:67]
    v_mfma_f32_16x16x32_bf16 v[68:71], v[204:207], v[240:243], v[68:71]
    v_mfma_f32_16x16x32_bf16 v[72:75], v[204:207], v[244:247], v[72:75]
    v_mfma_f32_16x16x32_bf16 v[76:79], v[204:207], v[248:251], v[76:79]
    v_mfma_f32_16x16x32_bf16 v[80:83], v[204:207], v[252:255], v[80:83]
    v_mfma_f32_16x16x32_bf16 v[84:87], v[204:207], v[88:91], v[84:87]
    v_mfma_f32_16x16x32_bf16 v[64:67], v[208:211], v[232:235], v[64:67]
    v_mfma_f32_16x16x32_bf16 v[68:71], v[208:211], v[236:239], v[68:71]
    v_mfma_f32_16x16x32_bf16 v[72:75], v[208:211], v[240:243], v[72:75]
    v_mfma_f32_16x16x32_bf16 v[76:79], v[208:211], v[244:247], v[76:79]
    v_mfma_f32_16x16x32_bf16 v[80:83], v[208:211], v[248:251], v[80:83]
    v_mfma_f32_16x16x32_bf16 v[84:87], v[208:211], v[252:255], v[84:87]
    v_mfma_f32_16x16x32_bf16 v[68:71], v[212:215], v[232:235], v[68:71]
    v_mfma_f32_16x16x32_bf16 v[72:75], v[212:215], v[236:239], v[72:75]
    v_mfma_f32_16x16x32_bf16 v[76:79], v[212:215], v[240:243], v[76:79]
    v_mfma_f32_16x16x32_bf16 v[80:83], v[212:215], v[244:247], v[80:83]
    v_mfma_f32_16x16x32_bf16 v[84:87], v[212:215], v[248:251], v[84:87]
    v_mfma_f32_16x16x32_bf16 v[72:75], v[216:219], v[232:235], v[72:75]
    v_mfma_f32_16x16x32_bf16 v[76:79], v[216:219], v[236:239], v[76:79]
    v_mfma_f32_16x16x32_bf16 v[80:83], v[216:219], v[240:243], v[80:83]
    v_mfma_f32_16x16x32_bf16 v[84:87], v[216:219], v[244:247], v[84:87]
    v_mfma_f32_16x16x32_bf16 v[76:79], v[220:223], v[232:235], v[76:79]
    v_mfma_f32_16x16x32_bf16 v[80:83], v[220:223], v[236:239], v[80:83]
    v_mfma_f32_16x16x32_bf16 v[84:87], v[220:223], v[240:243], v[84:87]
    v_mfma_f32_16x16x32_bf16 v[80:83], v[224:227], v[232:235], v[80:83]
    v_mfma_f32_16x16x32_bf16 v[84:87], v[224:227], v[236:239], v[84:87]
    v_mfma_f32_16x16x32_bf16 v[84:87], v[228:231], v[232:235], v[84:87]
    s_setprio 1
    s_barrier
    v_bfe_u32 v3, v0, 2, 2
    v_lshlrev_b32 v4, 1, v0
    v_xor_b32 v3, v3, v4
    v_lshlrev_b32 v3, 4, v3
    v_xor_b32 v4, 16, v3
    ds_write_b128 v98, v[56:59] offset:0
    ds_write_b128 v98, v[60:63] offset:1024
    ds_write_b128 v98, v[64:67] offset:2048
    ds_write_b128 v98, v[68:71] offset:3072
    ds_write_b128 v98, v[72:75] offset:4096
    ds_write_b128 v98, v[76:79] offset:5120
    ds_write_b128 v98, v[80:83] offset:6144
    ds_write_b128 v98, v[84:87] offset:7168
    s_waitcnt lgkmcnt(0)
    s_barrier
    ds_read_b128 v[136:139], v3 offset:34816
    ds_read_b128 v[140:143], v4 offset:34816
    ds_read_b128 v[144:147], v3 offset:43008
    ds_read_b128 v[148:151], v4 offset:43008
    ds_read_b128 v[152:155], v3 offset:51200
    ds_read_b128 v[156:159], v4 offset:51200
    ds_read_b128 v[160:163], v3 offset:59392
    ds_read_b128 v[164:167], v4 offset:59392
    s_waitcnt lgkmcnt(4)
    v_add_f32 v136, v136, v144
    v_add_f32 v137, v137, v145
    v_add_f32 v138, v138, v146
    v_add_f32 v139, v139, v147
    v_add_f32 v140, v140, v148
    v_add_f32 v141, v141, v149
    v_add_f32 v142, v142, v150
    v_add_f32 v143, v143, v151
    v_cvt_pk_bf16_f32 v48, v136, v137
    v_cvt_pk_bf16_f32 v49, v138, v139
    v_cvt_pk_bf16_f32 v50, v140, v141
    v_cvt_pk_bf16_f32 v51, v142, v143
    buffer_store_dwordx4 v[48:51], v47, s[20:23], 0 offen offset:0
    s_waitcnt lgkmcnt(0)
    v_add_f32 v152, v152, v160
    v_add_f32 v153, v153, v161
    v_add_f32 v154, v154, v162
    v_add_f32 v155, v155, v163
    v_add_f32 v156, v156, v164
    v_add_f32 v157, v157, v165
    v_add_f32 v158, v158, v166
    v_add_f32 v159, v159, v167
    v_cvt_pk_bf16_f32 v52, v152, v153
    v_cvt_pk_bf16_f32 v53, v154, v155
    v_cvt_pk_bf16_f32 v54, v156, v157
    v_cvt_pk_bf16_f32 v55, v158, v159
    buffer_store_dwordx4 v[52:55], v47, s[20:23], 0 offen offset:2048
    v_lshrrev_b32 v5, 3, v0
    v_and_b32 v6, 7, v0
    v_xor_b32 v6, s34, v6
    v_lshlrev_b32 v6, 4, v6
    v_lshl_add_u32 v5, v5, 11, v6
    s_lshl_b32 s36, s33, 17
    s_lshl_b32 s37, s32, 7
    s_add_u32 s36, s36, s37
    v_add_u32 v5, s36, v5
    v_xor_b32 v6, 64, v5
    v_add_u32 v6, 65536, v6
    s_waitcnt vmcnt(0)
    s_mov_b64 exec, 1
    buffer_store_dword v11, v10, s[24:27], 0 offen
    s_mov_b64 exec, -1
    s_barrier
    ds_read_b32 v60, v44 offset:17408
    ds_read_b32 v61, v44 offset:17536
    ds_read_b32 v62, v44 offset:17664
    ds_read_b32 v63, v44 offset:17792
    ds_read_b32 v64, v44 offset:17920
    ds_read_b32 v65, v44 offset:18048
    ds_read_b32 v66, v44 offset:18176
    ds_read_b32 v67, v44 offset:18304
    s_waitcnt lgkmcnt(0)
    v_lshlrev_b32 v100, 16, v60
    v_and_b32 v101, 0xffff0000, v60
    v_lshlrev_b32 v102, 16, v61
    v_and_b32 v103, 0xffff0000, v61
    v_lshlrev_b32 v104, 16, v62
    v_and_b32 v105, 0xffff0000, v62
    v_lshlrev_b32 v106, 16, v63
    v_and_b32 v107, 0xffff0000, v63
    v_lshlrev_b32 v108, 16, v64
    v_and_b32 v109, 0xffff0000, v64
    v_lshlrev_b32 v110, 16, v65
    v_and_b32 v111, 0xffff0000, v65
    v_lshlrev_b32 v112, 16, v66
    v_and_b32 v113, 0xffff0000, v66
    v_lshlrev_b32 v114, 16, v67
    v_and_b32 v115, 0xffff0000, v67
    v_mul_f32 v116, v116, v100
    v_mul_f32 v117, v117, v101
    v_mul_f32 v118, v118, v102
    v_mul_f32 v119, v119, v103
    v_mul_f32 v120, v120, v104
    v_mul_f32 v121, v121, v105
    v_mul_f32 v122, v122, v106
    v_mul_f32 v123, v123, v107
    v_mul_f32 v124, v124, v108
    v_mul_f32 v125, v125, v109
    v_mul_f32 v126, v126, v110
    v_mul_f32 v127, v127, v111
    v_mul_f32 v128, v128, v112
    v_mul_f32 v129, v129, v113
    v_mul_f32 v130, v130, v114
    v_mul_f32 v131, v131, v115
    s_mov_b32 s41, s45
L_a_poll3:
    buffer_load_dwordx2 v[12:13], v99, s[24:27], 0 offen sc1
    s_waitcnt vmcnt(0)
    v_cmp_ne_u32 vcc, s44, v12
    v_cmp_ne_u32 s[42:43], s44, v13
    s_sub_u32 s41, s41, 1
    s_or_b64 vcc, vcc, s[42:43]
    s_cbranch_scc0 L_a_poll3_x
    s_sleep 8
    s_cmp_gt_i32 s41, 0
    s_cbranch_scc1 L_a_poll3
    s_branch L_a_poll3_r
L_a_poll3_x:
    buffer_load_dwordx4 v[136:139], v46, s[20:23], 0 offen offset:0 sc1
    buffer_load_dwordx4 v[140:143], v46, s[20:23], 0 offen offset:2048 sc1
    s_waitcnt vmcnt(1)
    v_lshlrev_b32 v144, 16, v136
    v_and_b32 v146, 0xffff0000, v136
    v_lshlrev_b32 v148, 16, v137
    v_and_b32 v150, 0xffff0000, v137
    v_lshlrev_b32 v152, 16, v138
    v_and_b32 v154, 0xffff0000, v138
    v_lshlrev_b32 v156, 16, v139
    v_and_b32 v158, 0xffff0000, v139
    s_waitcnt vmcnt(0)
    v_lshlrev_b32 v145, 16, v140
    v_and_b32 v147, 0xffff0000, v140
    v_lshlrev_b32 v149, 16, v141
    v_and_b32 v151, 0xffff0000, v141
    v_lshlrev_b32 v153, 16, v142
    v_and_b32 v155, 0xffff0000, v142
    v_lshlrev_b32 v157, 16, v143
    v_and_b32 v159, 0xffff0000, v143
    v_fmac_f32 v116, v144, v100
    v_fmac_f32 v117, v145, v101
    v_cvt_pk_bf16_f32 v136, v116, v117
    ds_write_b32 v44, v136 offset:0
    v_fmac_f32 v118, v146, v102
    v_fmac_f32 v119, v147, v103
    v_cvt_pk_bf16_f32 v137, v118, v119
    ds_write_b32 v44, v137 offset:128
    v_fmac_f32 v120, v148, v104
    v_fmac_f32 v121, v149, v105
    v_cvt_pk_bf16_f32 v138, v120, v121
    ds_write_b32 v44, v138 offset:256
    v_fmac_f32 v122, v150, v106
    v_fmac_f32 v123, v151, v107
    v_cvt_pk_bf16_f32 v139, v122, v123
    ds_write_b32 v44, v139 offset:384
    v_fmac_f32 v124, v152, v108
    v_fmac_f32 v125, v153, v109
    v_cvt_pk_bf16_f32 v140, v124, v125
    ds_write_b32 v44, v140 offset:512
    v_fmac_f32 v126, v154, v110
    v_fmac_f32 v127, v155, v111
    v_cvt_pk_bf16_f32 v141, v126, v127
    ds_write_b32 v44, v141 offset:640
    v_fmac_f32 v128, v156, v112
    v_fmac_f32 v129, v157, v113
    v_cvt_pk_bf16_f32 v142, v128, v129
    ds_write_b32 v44, v142 offset:768
    v_fmac_f32 v130, v158, v114
    v_fmac_f32 v131, v159, v115
    v_cvt_pk_bf16_f32 v143, v130, v131
    ds_write_b32 v44, v143 offset:896
    s_waitcnt lgkmcnt(0)
    s_barrier
    ds_read_b128 v[144:147], v2 offset:0
    ds_read_b128 v[148:151], v2 offset:4096
    s_waitcnt lgkmcnt(1)
    buffer_store_dwordx4 v[144:147], v5, s[20:23], 0 offen
    s_waitcnt lgkmcnt(0)
    buffer_store_dwordx4 v[148:151], v6, s[20:23], 0 offen
    s_or_b32 s35, s33, s34
    s_cbranch_scc1 L_a_noepoch
    s_lshl2_add_u32 s35, s32, 7340032
    v_mov_b32 v12, s35
    v_mov_b32 v13, s40
    s_mov_b64 exec, 1
    buffer_store_dword v13, v12, s[24:27], 0 offen
    s_mov_b64 exec, -1
L_a_noepoch:
L_end:
    s_endpgm
L_b_fx0:
    v_cvt_pk_bf16_f32 v167, v142, v143
    s_nop 1
    v_mfma_f32_32x32x16_bf16 v[208:223], v[68:71], v[164:167], v[208:223]
    s_add_u32 m0, s52, 0
    s_add_u32 s32, s53, 0
    buffer_load_dwordx4 v244, s[12:15], s32 offen lds
    buffer_load_dwordx4 v245, s[12:15], s32 offen offset:1024 lds
    buffer_load_dwordx4 v246, s[12:15], s32 offen offset:2048 lds
    buffer_load_dwordx4 v247, s[12:15], s32 offen offset:3072 lds
    s_mov_b64 exec, 0xffff
    buffer_load_dword v254, v253, s[16:19], s45 offen sc1
    s_mov_b64 exec, -1
    s_add_u32 m0, s52, 4096
    s_add_u32 s32, s53, 32768
    buffer_load_dwordx4 v244, s[12:15], s32 offen lds
    buffer_load_dwordx4 v245, s[12:15], s32 offen offset:1024 lds
    buffer_load_dwordx4 v246, s[12:15], s32 offen offset:2048 lds
    buffer_load_dwordx4 v247, s[12:15], s32 offen offset:3072 lds
    s_add_u32 m0, s52, 8192
    s_add_u32 s32, s53, 65536
    buffer_load_dwordx4 v244, s[12:15], s32 offen lds
    buffer_load_dwordx4 v245, s[12:15], s32 offen offset:1024 lds
    buffer_load_dwordx4 v246, s[12:15], s32 offen offset:2048 lds
    buffer_load_dwordx4 v247, s[12:15], s32 offen offset:3072 lds
    s_add_u32 m0, s52, 12288
    s_add_u32 s32, s53, 98304
    buffer_load_dwordx4 v244, s[12:15], s32 offen lds
    buffer_load_dwordx4 v245, s[12:15], s32 offen offset:1024 lds
    buffer_load_dwordx4 v246, s[12:15], s32 offen offset:2048 lds
    buffer_load_dwordx4 v247, s[12:15], s32 offen offset:3072 lds
    s_nop 9
    s_branch L_b_fdone
L_b_fx1:
    v_cvt_pk_bf16_f32 v167, v142, v143
    s_nop 1
    v_mfma_f32_32x32x16_bf16 v[208:223], v[52:55], v[164:167], v[208:223]
    s_add_u32 m0, s52, 4096
    s_add_u32 s32, s53, 32768
    buffer_load_dwordx4 v244, s[12:15], s32 offen lds
    buffer_load_dwordx4 v245, s[12:15], s32 offen offset:1024 lds
    buffer_load_dwordx4 v246, s[12:15], s32 offen offset:2048 lds
    buffer_load_dwordx4 v247, s[12:15], s32 offen offset:3072 lds
    s_add_u32 m0, s52, 8192
    s_add_u32 s32, s53, 65536
    buffer_load_dwordx4 v244, s[12:15], s32 offen lds
    buffer_load_dwordx4 v245, s[12:15], s32 offen offset:1024 lds
    buffer_load_dwordx4 v246, s[12:15], s32 offen offset:2048 lds
    buffer_load_dwordx4 v247, s[12:15], s32 offen offset:3072 lds
    s_add_u32 m0, s52, 12288
    s_add_u32 s32, s53, 98304
    buffer_load_dwordx4 v244, s[12:15], s32 offen lds
    buffer_load_dwordx4 v245, s[12:15], s32 offen offset:1024 lds
    buffer_load_dwordx4 v246, s[12:15], s32 offen offset:2048 lds
    buffer_load_dwordx4 v247, s[12:15], s32 offen offset:3072 lds
    s_nop 9
    s_branch L_b_fdone
L_b_fx2:
    v_cvt_pk_bf16_f32 v167, v142, v143
    s_nop 1
    v_mfma_f32_32x32x16_bf16 v[208:223], v[36:39], v[164:167], v[208:223]
    s_add_u32 m0, s52, 8192
    s_add_u32 s32, s53, 65536
    buffer_load_dwordx4 v244, s[12:15], s32 offen lds
    buffer_load_dwordx4 v245, s[12:15], s32 offen offset:1024 lds
    buffer_load_dwordx4 v246, s[12:15], s32 offen offset:2048 lds
    buffer_load_dwordx4 v247, s[12:15], s32 offen offset:3072 lds
    s_add_u32 m0, s52, 12288
    s_add_u32 s32, s53, 98304
    buffer_load_dwordx4 v244, s[12:15], s32 offen lds
    buffer_load_dwordx4 v245, s[12:15], s32 offen offset:1024 lds
    buffer_load_dwordx4 v246, s[12:15], s32 offen offset:2048 lds
    buffer_load_dwordx4 v247, s[12:15], s32 offen offset:3072 lds
    s_nop 9
    s_branch L_b_fdone
L_b_fx3:
    v_cvt_pk_bf16_f32 v167, v142, v143
    s_nop 1
    v_mfma_f32_32x32x16_bf16 v[208:223], v[20:23], v[164:167], v[208:223]
    s_nop 9
    s_branch L_b_fdone
L_b_poll4_r:
    buffer_wbl2 sc1
    s_waitcnt vmcnt(0)
    v_mov_b32 v228, s50
    v_mov_b32 v229, s43
    s_mov_b32 s37, 12288
    s_mov_b64 exec, 1
    buffer_store_dword v229, v228, s[20:23], s37 offen sc1
    s_mov_b64 exec, -1
    s_mov_b32 s47, 200000
L_b_poll4_gl:
    buffer_load_dword v228, v249, s[20:23], 0 offen sc1
    buffer_load_dword v230, v249, s[20:23], s37 offen sc1
    s_waitcnt vmcnt(0)
    v_cmp_ne_u32 vcc, s46, v228
    v_cmp_ne_u32 s[38:39], s43, v230
    s_sub_u32 s47, s47, 1
    s_and_b64 vcc, vcc, s[38:39]
    s_cbranch_scc0 L_b_poll4_gx
L_b_poll4_gr:
    s_sleep 2
    s_cmp_lg_u32 s47, 0
    s_cbranch_scc1 L_b_poll4_gl
L_b_poll4_gx:
    s_mov_b32 s47, 0
    buffer_inv sc1
    s_waitcnt vmcnt(0)
    s_branch L_b_poll4_x
L_b_poll6_r:
    buffer_wbl2 sc1
    s_waitcnt vmcnt(0)
    v_mov_b32 v232, s50
    v_mov_b32 v233, s43
    s_mov_b32 s37, 12288
    s_mov_b64 exec, 1
    buffer_store_dword v233, v232, s[20:23], s37 offen sc1
    s_mov_b64 exec, -1
    s_mov_b32 s47, 200000
L_b_poll6_gl:
    buffer_load_dword v232, v249, s[20:23], 0 offen sc1
    buffer_load_dword v234, v249, s[20:23], s37 offen sc1
    s_waitcnt vmcnt(0)
    v_cmp_ne_u32 vcc, s46, v232
    v_cmp_ne_u32 s[38:39], s43, v234
    s_sub_u32 s47, s47, 1
    s_and_b64 vcc, vcc, s[38:39]
    s_cbranch_scc0 L_b_poll6_gx
L_b_poll6_gr:
    s_sleep 2
    s_cmp_lg_u32 s47, 0
    s_cbranch_scc1 L_b_poll6_gl
L_b_poll6_gx:
    s_mov_b32 s47, 0
    buffer_inv sc1
    s_waitcnt vmcnt(0)
    s_branch L_b_poll6_x
L_a_touch:
    s_movk_i32 s38, 4096
    s_waitcnt vmcnt(0)
    buffer_load_dwordx2 v[14:15], v99, s[24:27], s38 offen sc1
    buffer_load_dwordx2 v[12:13], v99, s[24:27], 0 offen sc1
    s_branch L_a_touch_x
L_a_poll1_r:
    buffer_wbl2 sc1
    s_waitcnt vmcnt(0)
    v_mov_b32 v12, s46
    v_mov_b32 v13, s40
    s_mov_b32 s41, 12288
    s_mov_b64 exec, 1
    buffer_store_dword v13, v12, s[24:27], s41 offen sc1
    s_mov_b64 exec, -1
    s_mov_b32 s45, 200000
L_a_poll1_gl:
    buffer_load_dwordx2 v[12:13], v99, s[24:27], 0 offen sc1
    buffer_load_dwordx2 v[14:15], v99, s[24:27], s41 offen sc1
    s_waitcnt vmcnt(0)
    v_cmp_ne_u32 vcc, s44, v12
    v_cmp_ne_u32 s[42:43], s40, v14
    s_sub_u32 s45, s45, 1
    s_and_b64 vcc, vcc, s[42:43]
    s_cbranch_scc1 L_a_poll1_gr
    v_cmp_ne_u32 vcc, s44, v13
    v_cmp_ne_u32 s[42:43], s40, v15
    s_nop 0
    s_and_b64 vcc, vcc, s[42:43]
    s_cbranch_scc0 L_a_poll1_gx
L_a_poll1_gr:
    s_sleep 2
    s_cmp_lg_u32 s45, 0
    s_cbranch_scc1 L_a_poll1_gl
L_a_poll1_gx:
    s_mov_b32 s45, 0
    buffer_inv sc1
    s_waitcnt vmcnt(0)
    s_branch L_a_poll1_x
L_a_poll3_r:
    buffer_wbl2 sc1
    s_waitcnt vmcnt(0)
    v_mov_b32 v12, s46
    v_mov_b32 v13, s40
    s_mov_b32 s41, 12288
    s_mov_b64 exec, 1
    buffer_store_dword v13, v12, s[24:27], s41 offen sc1
    s_mov_b64 exec, -1
    s_mov_b32 s45, 200000
L_a_poll3_gl:
    buffer_load_dwordx2 v[12:13], v99, s[24:27], 0 offen sc1
    buffer_load_dwordx2 v[14:15], v99, s[24:27], s41 offen sc1
    s_waitcnt vmcnt(0)
    v_cmp_ne_u32 vcc, s44, v12
    v_cmp_ne_u32 s[42:43], s40, v14
    s_sub_u32 s45, s45, 1
    s_and_b64 vcc, vcc, s[42:43]
    s_cbranch_scc1 L_a_poll3_gr
    v_cmp_ne_u32 vcc, s44, v13
    v_cmp_ne_u32 s[42:43], s40, v15
    s_nop 0
    s_and_b64 vcc, vcc, s[42:43]
    s_cbranch_scc0 L_a_poll3_gx
L_a_poll3_gr:
    s_sleep 2
    s_cmp_lg_u32 s45, 0
    s_cbranch_scc1 L_a_poll3_gl
L_a_poll3_gx:
    s_mov_b32 s45, 0
    buffer_inv sc1
    s_waitcnt vmcnt(0)
    s_branch L_a_poll3_x
L_hot_end:
L_b_slow:
    s_lshl1_add_u32 s40, s26, 0
    v_mov_b32 v250, 0xf149f2ca
    s_nop 0
    v_mfma_f32_32x32x16_bf16 v[128:143], v[112:115], v[120:123], v[224:239]
    v_mfma_f32_32x32x16_bf16 v[144:159], v[108:111], v[120:123], 0
    s_nop 10
    v_max3_f32 v250, v128, v129, v250
    v_max3_f32 v250, v130, v131, v250
    v_max3_f32 v250, v132, v133, v250
    v_max3_f32 v250, v134, v135, v250
    v_max3_f32 v250, v136, v137, v250
    v_max3_f32 v250, v138, v139, v250
    v_max3_f32 v250, v140, v141, v250
    v_max3_f32 v250, v142, v143, v250
    s_cmp_le_u32 s40, 0
    s_cbranch_scc1 L_b_p1done0
    v_mfma_f32_32x32x16_bf16 v[128:143], v[104:107], v[120:123], 0
    s_nop 1
    v_max3_f32 v250, v144, v145, v250
    v_max3_f32 v250, v146, v147, v250
    v_max3_f32 v250, v148, v149, v250
    v_max3_f32 v250, v150, v151, v250
    v_max3_f32 v250, v152, v153, v250
    v_max3_f32 v250, v154, v155, v250
    v_max3_f32 v250, v156, v157, v250
    v_max3_f32 v250, v158, v159, v250
    s_cmp_le_u32 s40, 1
    s_cbranch_scc1 L_b_p1done0
    v_mfma_f32_32x32x16_bf16 v[144:159], v[100:103], v[120:123], 0
    s_nop 1
    v_max3_f32 v250, v128, v129, v250
    v_max3_f32 v250, v130, v131, v250
    v_max3_f32 v250, v132, v133, v250
    v_max3_f32 v250, v134, v135, v250
    v_max3_f32 v250, v136, v137, v250
    v_max3_f32 v250, v138, v139, v250
    v_max3_f32 v250, v140, v141, v250
    v_max3_f32 v250, v142, v143, v250
    s_cmp_le_u32 s40, 2
    s_cbranch_scc1 L_b_p1done0
    v_mfma_f32_32x32x16_bf16 v[128:143], v[96:99], v[120:123], 0
    s_nop 1
    v_max3_f32 v250, v144, v145, v250
    v_max3_f32 v250, v146, v147, v250
    v_max3_f32 v250, v148, v149, v250
    v_max3_f32 v250, v150, v151, v250
    v_max3_f32 v250, v152, v153, v250
    v_max3_f32 v250, v154, v155, v250
    v_max3_f32 v250, v156, v157, v250
    v_max3_f32 v250, v158, v159, v250
    s_cmp_le_u32 s40, 3
    s_cbranch_scc1 L_b_p1done0
    v_mfma_f32_32x32x16_bf16 v[144:159], v[92:95], v[120:123], 0
    s_nop 1
    v_max3_f32 v250, v128, v129, v250
    v_max3_f32 v250, v130, v131, v250
    v_max3_f32 v250, v132, v133, v250
    v_max3_f32 v250, v134, v135, v250
    v_max3_f32 v250, v136, v137, v250
    v_max3_f32 v250, v138, v139, v250
    v_max3_f32 v250, v140, v141, v250
    v_max3_f32 v250, v142, v143, v250
    s_cmp_le_u32 s40, 4
    s_cbranch_scc1 L_b_p1done0
    v_mfma_f32_32x32x16_bf16 v[128:143], v[88:91], v[120:123], 0
    s_nop 1
    v_max3_f32 v250, v144, v145, v250
    v_max3_f32 v250, v146, v147, v250
    v_max3_f32 v250, v148, v149, v250
    v_max3_f32 v250, v150, v151, v250
    v_max3_f32 v250, v152, v153, v250
    v_max3_f32 v250, v154, v155, v250
    v_max3_f32 v250, v156, v157, v250
    v_max3_f32 v250, v158, v159, v250
    s_cmp_le_u32 s40, 5
    s_cbranch_scc1 L_b_p1done0
    v_mfma_f32_32x32x16_bf16 v[144:159], v[84:87], v[120:123], 0
    s_nop 1
    v_max3_f32 v250, v128, v129, v250
    v_max3_f32 v250, v130, v131, v250
    v_max3_f32 v250, v132, v133, v250
    v_max3_f32 v250, v134, v135, v250
    v_max3_f32 v250, v136, v137, v250
    v_max3_f32 v250, v138, v139, v250
    v_max3_f32 v250, v140, v141, v250
    v_max3_f32 v250, v142, v143, v250
    s_cmp_le_u32 s40, 6
    s_cbranch_scc1 L_b_p1done0
    v_mfma_f32_32x32x16_bf16 v[128:143], v[80:83], v[120:123], v[168:183]
    s_nop 1
    v_max3_f32 v250, v144, v145, v250
    v_max3_f32 v250, v146, v147, v250
    v_max3_f32 v250, v148, v149, v250
    v_max3_f32 v250, v150, v151, v250
    v_max3_f32 v250, v152, v153, v250
    v_max3_f32 v250, v154, v155, v250
    v_max3_f32 v250, v156, v157, v250
    v_max3_f32 v250, v158, v159, v250
    s_cmp_le_u32 s40, 7
    s_cbranch_scc1 L_b_p1done0
    s_nop 1
    v_max3_f32 v250, v128, v129, v250
    v_max3_f32 v250, v130, v131, v250
    v_max3_f32 v250, v132, v133, v250
    v_max3_f32 v250, v134, v135, v250
    v_max3_f32 v250, v136, v137, v250
    v_max3_f32 v250, v138, v139, v250
    v_max3_f32 v250, v140, v141, v250
    v_max3_f32 v250, v142, v143, v250
L_b_p1done0:
    v_mov_b32 v252, v250
    s_nop 1
    v_permlane32_swap_b32 v250, v252
    v_max_f32 v250, v250, v252
    v_sub_f32 v208, 0, v250
    v_sub_f32 v209, 0, v250
    v_sub_f32 v210, 0, v250
    v_sub_f32 v211, 0, v250
    v_sub_f32 v212, 0, v250
    v_sub_f32 v213, 0, v250
    v_sub_f32 v214, 0, v250
    v_sub_f32 v215, 0, v250
    v_sub_f32 v216, 0, v250
    v_sub_f32 v217, 0, v250
    v_sub_f32 v218, 0, v250
    v_sub_f32 v219, 0, v250
    v_sub_f32 v220, 0, v250
    v_sub_f32 v221, 0, v250
    v_sub_f32 v222, 0, v250
    v_sub_f32 v223, 0, v250
    v_sub_f32 v128, v224, v250
    v_sub_f32 v129, v225, v250
    v_sub_f32 v130, v226, v250
    v_sub_f32 v131, v227, v250
    v_sub_f32 v132, v228, v250
    v_sub_f32 v133, v229, v250
    v_sub_f32 v134, v230, v250
    v_sub_f32 v135, v231, v250
    v_sub_f32 v136, v232, v250
    v_sub_f32 v137, v233, v250
    v_sub_f32 v138, v234, v250
    v_sub_f32 v139, v235, v250
    v_sub_f32 v140, v236, v250
    v_sub_f32 v141, v237, v250
    v_sub_f32 v142, v238, v250
    v_sub_f32 v143, v239, v250
    s_nop 1
    v_mfma_f32_32x32x16_bf16 v[128:143], v[112:115], v[120:123], v[128:143]
    v_mfma_f32_32x32x16_bf16 v[144:159], v[108:111], v[120:123], v[208:223]
    s_nop 10
    v_exp_f32 v128, v128
    v_exp_f32 v129, v129
    v_exp_f32 v130, v130
    v_exp_f32 v131, v131
    v_exp_f32 v132, v132
    v_exp_f32 v133, v133
    v_exp_f32 v134, v134
    v_exp_f32 v135, v135
    v_cvt_pk_bf16_f32 v160, v128, v129
    v_cvt_pk_bf16_f32 v161, v130, v131
    v_cvt_pk_bf16_f32 v162, v132, v133
    v_cvt_pk_bf16_f32 v163, v134, v135
    s_nop 1
    v_mfma_f32_32x32x16_bf16 v[192:207], v[64:67], v[160:163], 0
    v_exp_f32 v136, v136
    v_exp_f32 v137, v137
    v_exp_f32 v138, v138
    v_exp_f32 v139, v139
    v_exp_f32 v140, v140
    v_exp_f32 v141, v141
    v_exp_f32 v142, v142
    v_exp_f32 v143, v143
    v_cvt_pk_bf16_f32 v164, v136, v137
    v_cvt_pk_bf16_f32 v165, v138, v139
    v_cvt_pk_bf16_f32 v166, v140, v141
    v_cvt_pk_bf16_f32 v167, v142, v143
    s_nop 1
    v_mfma_f32_32x32x16_bf16 v[192:207], v[68:71], v[164:167], v[192:207]
    s_cmp_le_u32 s40, 0
    s_cbranch_scc1 L_b_p2done0
    v_mfma_f32_32x32x16_bf16 v[128:143], v[104:107], v[120:123], v[208:223]
    v_exp_f32 v144, v144
    v_exp_f32 v145, v145
    v_exp_f32 v146, v146
    v_exp_f32 v147, v147
    v_exp_f32 v148, v148
    v_exp_f32 v149, v149
    v_exp_f32 v150, v150
    v_exp_f32 v151, v151
    v_cvt_pk_bf16_f32 v160, v144, v145
    v_cvt_pk_bf16_f32 v161, v146, v147
    v_cvt_pk_bf16_f32 v162, v148, v149
    v_cvt_pk_bf16_f32 v163, v150, v151
    s_nop 1
    v_mfma_f32_32x32x16_bf16 v[192:207], v[56:59], v[160:163], v[192:207]
    v_exp_f32 v152, v152
    v_exp_f32 v153, v153
    v_exp_f32 v154, v154
    v_exp_f32 v155, v155
    v_exp_f32 v156, v156
    v_exp_f32 v157, v157
    v_exp_f32 v158, v158
    v_exp_f32 v159, v159
    v_cvt_pk_bf16_f32 v164, v152, v153
    v_cvt_pk_bf16_f32 v165, v154, v155
    v_cvt_pk_bf16_f32 v166, v156, v157
    v_cvt_pk_bf16_f32 v167, v158, v159
    s_nop 1
    v_mfma_f32_32x32x16_bf16 v[192:207], v[60:63], v[164:167], v[192:207]
    s_cmp_le_u32 s40, 1
    s_cbranch_scc1 L_b_p2done0
    v_mfma_f32_32x32x16_bf16 v[144:159], v[100:103], v[120:123], v[208:223]
    v_exp_f32 v128, v128
    v_exp_f32 v129, v129
    v_exp_f32 v130, v130
    v_exp_f32 v131, v131
    v_exp_f32 v132, v132
    v_exp_f32 v133, v133
    v_exp_f32 v134, v134
    v_exp_f32 v135, v135
    v_cvt_pk_bf16_f32 v160, v128, v129
    v_cvt_pk_bf16_f32 v161, v130, v131
    v_cvt_pk_bf16_f32 v162, v132, v133
    v_cvt_pk_bf16_f32 v163, v134, v135
    s_nop 1
    v_mfma_f32_32x32x16_bf16 v[192:207], v[48:51], v[160:163], v[192:207]
    v_exp_f32 v136, v136
    v_exp_f32 v137, v137
    v_exp_f32 v138, v138
    v_exp_f32 v139, v139
    v_exp_f32 v140, v140
    v_exp_f32 v141, v141
    v_exp_f32 v142, v142
    v_exp_f32 v143, v143
    v_cvt_pk_bf16_f32 v164, v136, v137
    v_cvt_pk_bf16_f32 v165, v138, v139
    v_cvt_pk_bf16_f32 v166, v140, v141
    v_cvt_pk_bf16_f32 v167, v142, v143
    s_nop 1
    v_mfma_f32_32x32x16_bf16 v[192:207], v[52:55], v[164:167], v[192:207]
    s_cmp_le_u32 s40, 2
    s_cbranch_scc1 L_b_p2done0
    v_mfma_f32_32x32x16_bf16 v[128:143], v[96:99], v[120:123], v[208:223]
    v_exp_f32 v144, v144
    v_exp_f32 v145, v145
    v_exp_f32 v146, v146
    v_exp_f32 v147, v147
    v_exp_f32 v148, v148
    v_exp_f32 v149, v149
    v_exp_f32 v150, v150
    v_exp_f32 v151, v151
    v_cvt_pk_bf16_f32 v160, v144, v145
    v_cvt_pk_bf16_f32 v161, v146, v147
    v_cvt_pk_bf16_f32 v162, v148, v149
    v_cvt_pk_bf16_f32 v163, v150, v151
    s_nop 1
    v_mfma_f32_32x32x16_bf16 v[192:207], v[40:43], v[160:163], v[192:207]
    v_exp_f32 v152, v152
    v_exp_f32 v153, v153
    v_exp_f32 v154, v154
    v_exp_f32 v155, v155
    v_exp_f32 v156, v156
    v_exp_f32 v157, v157
    v_exp_f32 v158, v158
    v_exp_f32 v159, v159
    v_cvt_pk_bf16_f32 v164, v152, v153
    v_cvt_pk_bf16_f32 v165, v154, v155
    v_cvt_pk_bf16_f32 v166, v156, v157
    v_cvt_pk_bf16_f32 v167, v158, v159
    s_nop 1
    v_mfma_f32_32x32x16_bf16 v[192:207], v[44:47], v[164:167], v[192:207]
    s_cmp_le_u32 s40, 3
    s_cbranch_scc1 L_b_p2done0
    v_mfma_f32_32x32x16_bf16 v[144:159], v[92:95], v[120:123], v[208:223]
    v_exp_f32 v128, v128
    v_exp_f32 v129, v129
    v_exp_f32 v130, v130
    v_exp_f32 v131, v131
    v_exp_f32 v132, v132
    v_exp_f32 v133, v133
    v_exp_f32 v134, v134
    v_exp_f32 v135, v135
    v_cvt_pk_bf16_f32 v160, v128, v129
    v_cvt_pk_bf16_f32 v161, v130, v131
    v_cvt_pk_bf16_f32 v162, v132, v133
    v_cvt_pk_bf16_f32 v163, v134, v135
    s_nop 1
    v_mfma_f32_32x32x16_bf16 v[192:207], v[32:35], v[160:163], v[192:207]
    v_exp_f32 v136, v136
    v_exp_f32 v137, v137
    v_exp_f32 v138, v138
    v_exp_f32 v139, v139
    v_exp_f32 v140, v140
    v_exp_f32 v141, v141
    v_exp_f32 v142, v142
    v_exp_f32 v143, v143
    v_cvt_pk_bf16_f32 v164, v136, v137
    v_cvt_pk_bf16_f32 v165, v138, v139
    v_cvt_pk_bf16_f32 v166, v140, v141
    v_cvt_pk_bf16_f32 v167, v142, v143
    s_nop 1
    v_mfma_f32_32x32x16_bf16 v[192:207], v[36:39], v[164:167], v[192:207]
    s_cmp_le_u32 s40, 4
    s_cbranch_scc1 L_b_p2done0
    v_mfma_f32_32x32x16_bf16 v[128:143], v[88:91], v[120:123], v[208:223]
    v_exp_f32 v144, v144
    v_exp_f32 v145, v145
    v_exp_f32 v146, v146
    v_exp_f32 v147, v147
    v_exp_f32 v148, v148
    v_exp_f32 v149, v149
    v_exp_f32 v150, v150
    v_exp_f32 v151, v151
    v_cvt_pk_bf16_f32 v160, v144, v145
    v_cvt_pk_bf16_f32 v161, v146, v147
    v_cvt_pk_bf16_f32 v162, v148, v149
    v_cvt_pk_bf16_f32 v163, v150, v151
    s_nop 1
    v_mfma_f32_32x32x16_bf16 v[192:207], v[24:27], v[160:163], v[192:207]
    v_exp_f32 v152, v152
    v_exp_f32 v153, v153
    v_exp_f32 v154, v154
    v_exp_f32 v155, v155
    v_exp_f32 v156, v156
    v_exp_f32 v157, v157
    v_exp_f32 v158, v158
    v_exp_f32 v159, v159
    v_cvt_pk_bf16_f32 v164, v152, v153
    v_cvt_pk_bf16_f32 v165, v154, v155
    v_cvt_pk_bf16_f32 v166, v156, v157
    v_cvt_pk_bf16_f32 v167, v158, v159
    s_nop 1
    v_mfma_f32_32x32x16_bf16 v[192:207], v[28:31], v[164:167], v[192:207]
    s_cmp_le_u32 s40, 5
    s_cbranch_scc1 L_b_p2done0
    v_mfma_f32_32x32x16_bf16 v[144:159], v[84:87], v[120:123], v[208:223]
    v_exp_f32 v128, v128
    v_exp_f32 v129, v129
    v_exp_f32 v130, v130
    v_exp_f32 v131, v131
    v_exp_f32 v132, v132
    v_exp_f32 v133, v133
    v_exp_f32 v134, v134
    v_exp_f32 v135, v135
    v_cvt_pk_bf16_f32 v160, v128, v129
    v_cvt_pk_bf16_f32 v161, v130, v131
    v_cvt_pk_bf16_f32 v162, v132, v133
    v_cvt_pk_bf16_f32 v163, v134, v135
    s_nop 1
    v_mfma_f32_32x32x16_bf16 v[192:207], v[16:19], v[160:163], v[192:207]
    v_exp_f32 v136, v136
    v_exp_f32 v137, v137
    v_exp_f32 v138, v138
    v_exp_f32 v139, v139
    v_exp_f32 v140, v140
    v_exp_f32 v141, v141
    v_exp_f32 v142, v142
    v_exp_f32 v143, v143
    v_cvt_pk_bf16_f32 v164, v136, v137
    v_cvt_pk_bf16_f32 v165, v138, v139
    v_cvt_pk_bf16_f32 v166, v140, v141
    v_cvt_pk_bf16_f32 v167, v142, v143
    s_nop 1
    v_mfma_f32_32x32x16_bf16 v[192:207], v[20:23], v[164:167], v[192:207]
    s_cmp_le_u32 s40, 6
    s_cbranch_scc1 L_b_p2done0
    v_sub_f32 v128, v168, v250
    v_sub_f32 v129, v169, v250
    v_sub_f32 v130, v170, v250
    v_sub_f32 v131, v171, v250
    v_sub_f32 v132, v172, v250
    v_sub_f32 v133, v173, v250
    v_sub_f32 v134, v174, v250
    v_sub_f32 v135, v175, v250
    v_sub_f32 v136, v176, v250
    v_sub_f32 v137, v177, v250
    v_sub_f32 v138, v178, v250
    v_sub_f32 v139, v179, v250
    v_sub_f32 v140, v180, v250
    v_sub_f32 v141, v181, v250
    v_sub_f32 v142, v182, v250
    v_sub_f32 v143, v183, v250
    s_nop 1
    v_mfma_f32_32x32x16_bf16 v[128:143], v[80:83], v[120:123], v[128:143]
    v_exp_f32 v144, v144
    v_exp_f32 v145, v145
    v_exp_f32 v146, v146
    v_exp_f32 v147, v147
    v_exp_f32 v148, v148
    v_exp_f32 v149, v149
    v_exp_f32 v150, v150
    v_exp_f32 v151, v151
    v_cvt_pk_bf16_f32 v160, v144, v145
    v_cvt_pk_bf16_f32 v161, v146, v147
    v_cvt_pk_bf16_f32 v162, v148, v149
    v_cvt_pk_bf16_f32 v163, v150, v151
    s_nop 1
    v_mfma_f32_32x32x16_bf16 v[192:207], v[8:11], v[160:163], v[192:207]
    v_exp_f32 v152, v152
    v_exp_f32 v153, v153
    v_exp_f32 v154, v154
    v_exp_f32 v155, v155
    v_exp_f32 v156, v156
    v_exp_f32 v157, v157
    v_exp_f32 v158, v158
    v_exp_f32 v159, v159
    v_cvt_pk_bf16_f32 v164, v152, v153
    v_cvt_pk_bf16_f32 v165, v154, v155
    v_cvt_pk_bf16_f32 v166, v156, v157
    v_cvt_pk_bf16_f32 v167, v158, v159
    s_nop 1
    v_mfma_f32_32x32x16_bf16 v[192:207], v[12:15], v[164:167], v[192:207]
    s_cmp_le_u32 s40, 7
    s_cbranch_scc1 L_b_p2done0
    v_exp_f32 v128, v128
    v_exp_f32 v129, v129
    v_exp_f32 v130, v130
    v_exp_f32 v131, v131
    v_exp_f32 v132, v132
    v_exp_f32 v133, v133
    v_exp_f32 v134, v134
    v_exp_f32 v135, v135
    v_cvt_pk_bf16_f32 v160, v128, v129
    v_cvt_pk_bf16_f32 v161, v130, v131
    v_cvt_pk_bf16_f32 v162, v132, v133
    v_cvt_pk_bf16_f32 v163, v134, v135
    s_nop 1
    v_mfma_f32_32x32x16_bf16 v[192:207], v[0:3], v[160:163], v[192:207]
    v_exp_f32 v136, v136
    v_exp_f32 v137, v137
    v_exp_f32 v138, v138
    v_exp_f32 v139, v139
    v_exp_f32 v140, v140
    v_exp_f32 v141, v141
    v_exp_f32 v142, v142
    v_exp_f32 v143, v143
    v_cvt_pk_bf16_f32 v164, v136, v137
    v_cvt_pk_bf16_f32 v165, v138, v139
    v_cvt_pk_bf16_f32 v166, v140, v141
    v_cvt_pk_bf16_f32 v167, v142, v143
    s_nop 1
    v_mfma_f32_32x32x16_bf16 v[192:207], v[4:7], v[164:167], v[192:207]
L_b_p2done0:
    s_nop 11
    v_rcp_f32 v252, v200
    s_nop 0
    v_mul_f32 v192, v252, v192
    v_mul_f32 v193, v252, v193
    v_mul_f32 v194, v252, v194
    v_mul_f32 v195, v252, v195
    v_mul_f32 v196, v252, v196
    v_mul_f32 v197, v252, v197
    v_mul_f32 v198, v252, v198
    v_mul_f32 v199, v252, v199
    v_cvt_pk_bf16_f32 v128, v192, v193
    v_cvt_pk_bf16_f32 v129, v194, v195
    v_cvt_pk_bf16_f32 v130, v196, v197
    v_cvt_pk_bf16_f32 v131, v198, v199
    buffer_store_dwordx4 v[128:131], v184, s[16:19], s45 offen
    s_lshl1_add_u32 s40, s26, 1
    v_mov_b32 v250, 0xf149f2ca
    s_nop 0
    v_mfma_f32_32x32x16_bf16 v[128:143], v[116:119], v[124:127], v[224:239]
    v_mfma_f32_32x32x16_bf16 v[144:159], v[112:115], v[124:127], 0
    s_nop 10
    v_max3_f32 v250, v128, v129, v250
    v_max3_f32 v250, v130, v131, v250
    v_max3_f32 v250, v132, v133, v250
    v_max3_f32 v250, v134, v135, v250
    v_max3_f32 v250, v136, v137, v250
    v_max3_f32 v250, v138, v139, v250
    v_max3_f32 v250, v140, v141, v250
    v_max3_f32 v250, v142, v143, v250
    s_cmp_le_u32 s40, 0
    s_cbranch_scc1 L_b_p1done1
    v_mfma_f32_32x32x16_bf16 v[128:143], v[108:111], v[124:127], 0
    s_nop 1
    v_max3_f32 v250, v144, v145, v250
    v_max3_f32 v250, v146, v147, v250
    v_max3_f32 v250, v148, v149, v250
    v_max3_f32 v250, v150, v151, v250
    v_max3_f32 v250, v152, v153, v250
    v_max3_f32 v250, v154, v155, v250
    v_max3_f32 v250, v156, v157, v250
    v_max3_f32 v250, v158, v159, v250
    s_cmp_le_u32 s40, 1
    s_cbranch_scc1 L_b_p1done1
    v_mfma_f32_32x32x16_bf16 v[144:159], v[104:107], v[124:127], 0
    s_nop 1
    v_max3_f32 v250, v128, v129, v250
    v_max3_f32 v250, v130, v131, v250
    v_max3_f32 v250, v132, v133, v250
    v_max3_f32 v250, v134, v135, v250
    v_max3_f32 v250, v136, v137, v250
    v_max3_f32 v250, v138, v139, v250
    v_max3_f32 v250, v140, v141, v250
    v_max3_f32 v250, v142, v143, v250
    s_cmp_le_u32 s40, 2
    s_cbranch_scc1 L_b_p1done1
    v_mfma_f32_32x32x16_bf16 v[128:143], v[100:103], v[124:127], 0
    s_nop 1
    v_max3_f32 v250, v144, v145, v250
    v_max3_f32 v250, v146, v147, v250
    v_max3_f32 v250, v148, v149, v250
    v_max3_f32 v250, v150, v151, v250
    v_max3_f32 v250, v152, v153, v250
    v_max3_f32 v250, v154, v155, v250
    v_max3_f32 v250, v156, v157, v250
    v_max3_f32 v250, v158, v159, v250
    s_cmp_le_u32 s40, 3
    s_cbranch_scc1 L_b_p1done1
    v_mfma_f32_32x32x16_bf16 v[144:159], v[96:99], v[124:127], 0
    s_nop 1
    v_max3_f32 v250, v128, v129, v250
    v_max3_f32 v250, v130, v131, v250
    v_max3_f32 v250, v132, v133, v250
    v_max3_f32 v250, v134, v135, v250
    v_max3_f32 v250, v136, v137, v250
    v_max3_f32 v250, v138, v139, v250
    v_max3_f32 v250, v140, v141, v250
    v_max3_f32 v250, v142, v143, v250
    s_cmp_le_u32 s40, 4
    s_cbranch_scc1 L_b_p1done1
    v_mfma_f32_32x32x16_bf16 v[128:143], v[92:95], v[124:127], 0
    s_nop 1
    v_max3_f32 v250, v144, v145, v250
    v_max3_f32 v250, v146, v147, v250
    v_max3_f32 v250, v148, v149, v250
    v_max3_f32 v250, v150, v151, v250
    v_max3_f32 v250, v152, v153, v250
    v_max3_f32 v250, v154, v155, v250
    v_max3_f32 v250, v156, v157, v250
    v_max3_f32 v250, v158, v159, v250
    s_cmp_le_u32 s40, 5
    s_cbranch_scc1 L_b_p1done1
    v_mfma_f32_32x32x16_bf16 v[144:159], v[88:91], v[124:127], 0
    s_nop 1
    v_max3_f32 v250, v128, v129, v250
    v_max3_f32 v250, v130, v131, v250
    v_max3_f32 v250, v132, v133, v250
    v_max3_f32 v250, v134, v135, v250
    v_max3_f32 v250, v136, v137, v250
    v_max3_f32 v250, v138, v139, v250
    v_max3_f32 v250, v140, v141, v250
    v_max3_f32 v250, v142, v143, v250
    s_cmp_le_u32 s40, 6
    s_cbranch_scc1 L_b_p1done1
    v_mfma_f32_32x32x16_bf16 v[128:143], v[84:87], v[124:127], v[168:183]
    s_nop 1
    v_max3_f32 v250, v144, v145, v250
    v_max3_f32 v250, v146, v147, v250
    v_max3_f32 v250, v148, v149, v250
    v_max3_f32 v250, v150, v151, v250
    v_max3_f32 v250, v152, v153, v250
    v_max3_f32 v250, v154, v155, v250
    v_max3_f32 v250, v156, v157, v250
    v_max3_f32 v250, v158, v159, v250
    s_cmp_le_u32 s40, 7
    s_cbranch_scc1 L_b_p1done1
    s_nop 1
    v_max3_f32 v250, v128, v129, v250
    v_max3_f32 v250, v130, v131, v250
    v_max3_f32 v250, v132, v133, v250
    v_max3_f32 v250, v134, v135, v250
    v_max3_f32 v250, v136, v137, v250
    v_max3_f32 v250, v138, v139, v250
    v_max3_f32 v250, v140, v141, v250
    v_max3_f32 v250, v142, v143, v250
L_b_p1done1:
    v_mov_b32 v252, v250
    s_nop 1
    v_permlane32_swap_b32 v250, v252
    v_max_f32 v250, v250, v252
    v_sub_f32 v208, 0, v250
    v_sub_f32 v209, 0, v250
    v_sub_f32 v210, 0, v250
    v_sub_f32 v211, 0, v250
    v_sub_f32 v212, 0, v250
    v_sub_f32 v213, 0, v250
    v_sub_f32 v214, 0, v250
    v_sub_f32 v215, 0, v250
    v_sub_f32 v216, 0, v250
    v_sub_f32 v217, 0, v250
    v_sub_f32 v218, 0, v250
    v_sub_f32 v219, 0, v250
    v_sub_f32 v220, 0, v250
    v_sub_f32 v221, 0, v250
    v_sub_f32 v222, 0, v250
    v_sub_f32 v223, 0, v250
    v_sub_f32 v128, v224, v250
    v_sub_f32 v129, v225, v250
    v_sub_f32 v130, v226, v250
    v_sub_f32 v131, v227, v250
    v_sub_f32 v132, v228, v250
    v_sub_f32 v133, v229, v250
    v_sub_f32 v134, v230, v250
    v_sub_f32 v135, v231, v250
    v_sub_f32 v136, v232, v250
    v_sub_f32 v137, v233, v250
    v_sub_f32 v138, v234, v250
    v_sub_f32 v139, v235, v250
    v_sub_f32 v140, v236, v250
    v_sub_f32 v141, v237, v250
    v_sub_f32 v142, v238, v250
    v_sub_f32 v143, v239, v250
    s_nop 1
    v_mfma_f32_32x32x16_bf16 v[128:143], v[116:119], v[124:127], v[128:143]
    v_mfma_f32_32x32x16_bf16 v[144:159], v[112:115], v[124:127], v[208:223]
    s_nop 10
    v_exp_f32 v128, v128
    v_exp_f32 v129, v129
    v_exp_f32 v130, v130
    v_exp_f32 v131, v131
    v_exp_f32 v132, v132
    v_exp_f32 v133, v133
    v_exp_f32 v134, v134
    v_exp_f32 v135, v135
    v_cvt_pk_bf16_f32 v160, v128, v129
    v_cvt_pk_bf16_f32 v161, v130, v131
    v_cvt_pk_bf16_f32 v162, v132, v133
    v_cvt_pk_bf16_f32 v163, v134, v135
    s_nop 1
    v_mfma_f32_32x32x16_bf16 v[192:207], v[72:75], v[160:163], 0
    v_exp_f32 v136, v136
    v_exp_f32 v137, v137
    v_exp_f32 v138, v138
    v_exp_f32 v139, v139
    v_exp_f32 v140, v140
    v_exp_f32 v141, v141
    v_exp_f32 v142, v142
    v_exp_f32 v143, v143
    v_cvt_pk_bf16_f32 v164, v136, v137
    v_cvt_pk_bf16_f32 v165, v138, v139
    v_cvt_pk_bf16_f32 v166, v140, v141
    v_cvt_pk_bf16_f32 v167, v142, v143
    s_nop 1
    v_mfma_f32_32x32x16_bf16 v[192:207], v[76:79], v[164:167], v[192:207]
    s_cmp_le_u32 s40, 0
    s_cbranch_scc1 L_b_p2done1
    v_mfma_f32_32x32x16_bf16 v[128:143], v[108:111], v[124:127], v[208:223]
    v_exp_f32 v144, v144
    v_exp_f32 v145, v145
    v_exp_f32 v146, v146
    v_exp_f32 v147, v147
    v_exp_f32 v148, v148
    v_exp_f32 v149, v149
    v_exp_f32 v150, v150
    v_exp_f32 v151, v151
    v_cvt_pk_bf16_f32 v160, v144, v145
    v_cvt_pk_bf16_f32 v161, v146, v147
    v_cvt_pk_bf16_f32 v162, v148, v149
    v_cvt_pk_bf16_f32 v163, v150, v151
    s_nop 1
    v_mfma_f32_32x32x16_bf16 v[192:207], v[64:67], v[160:163], v[192:207]
    v_exp_f32 v152, v152
    v_exp_f32 v153, v153
    v_exp_f32 v154, v154
    v_exp_f32 v155, v155
    v_exp_f32 v156, v156
    v_exp_f32 v157, v157
    v_exp_f32 v158, v158
    v_exp_f32 v159, v159
    v_cvt_pk_bf16_f32 v164, v152, v153
    v_cvt_pk_bf16_f32 v165, v154, v155
    v_cvt_pk_bf16_f32 v166, v156, v157
    v_cvt_pk_bf16_f32 v167, v158, v159
    s_nop 1
    v_mfma_f32_32x32x16_bf16 v[192:207], v[68:71], v[164:167], v[192:207]
    s_cmp_le_u32 s40, 1
    s_cbranch_scc1 L_b_p2done1
    v_mfma_f32_32x32x16_bf16 v[144:159], v[104:107], v[124:127], v[208:223]
    v_exp_f32 v128, v128
    v_exp_f32 v129, v129
    v_exp_f32 v130, v130
    v_exp_f32 v131, v131
    v_exp_f32 v132, v132
    v_exp_f32 v133, v133
    v_exp_f32 v134, v134
    v_exp_f32 v135, v135
    v_cvt_pk_bf16_f32 v160, v128, v129
    v_cvt_pk_bf16_f32 v161, v130, v131
    v_cvt_pk_bf16_f32 v162, v132, v133
    v_cvt_pk_bf16_f32 v163, v134, v135
    s_nop 1
    v_mfma_f32_32x32x16_bf16 v[192:207], v[56:59], v[160:163], v[192:207]
    v_exp_f32 v136, v136
    v_exp_f32 v137, v137
    v_exp_f32 v138, v138
    v_exp_f32 v139, v139
    v_exp_f32 v140, v140
    v_exp_f32 v141, v141
    v_exp_f32 v142, v142
    v_exp_f32 v143, v143
    v_cvt_pk_bf16_f32 v164, v136, v137
    v_cvt_pk_bf16_f32 v165, v138, v139
    v_cvt_pk_bf16_f32 v166, v140, v141
    v_cvt_pk_bf16_f32 v167, v142, v143
    s_nop 1
    v_mfma_f32_32x32x16_bf16 v[192:207], v[60:63], v[164:167], v[192:207]
    s_cmp_le_u32 s40, 2
    s_cbranch_scc1 L_b_p2done1
    v_mfma_f32_32x32x16_bf16 v[128:143], v[100:103], v[124:127], v[208:223]
    v_exp_f32 v144, v144
    v_exp_f32 v145, v145
    v_exp_f32 v146, v146
    v_exp_f32 v147, v147
    v_exp_f32 v148, v148
    v_exp_f32 v149, v149
    v_exp_f32 v150, v150
    v_exp_f32 v151, v151
    v_cvt_pk_bf16_f32 v160, v144, v145
    v_cvt_pk_bf16_f32 v161, v146, v147
    v_cvt_pk_bf16_f32 v162, v148, v149
    v_cvt_pk_bf16_f32 v163, v150, v151
    s_nop 1
    v_mfma_f32_32x32x16_bf16 v[192:207], v[48:51], v[160:163], v[192:207]
    v_exp_f32 v152, v152
    v_exp_f32 v153, v153
    v_exp_f32 v154, v154
    v_exp_f32 v155, v155
    v_exp_f32 v156, v156
    v_exp_f32 v157, v157
    v_exp_f32 v158, v158
    v_exp_f32 v159, v159
    v_cvt_pk_bf16_f32 v164, v152, v153
    v_cvt_pk_bf16_f32 v165, v154, v155
    v_cvt_pk_bf16_f32 v166, v156, v157
    v_cvt_pk_bf16_f32 v167, v158, v159
    s_nop 1
    v_mfma_f32_32x32x16_bf16 v[192:207], v[52:55], v[164:167], v[192:207]
    s_cmp_le_u32 s40, 3
    s_cbranch_scc1 L_b_p2done1
    v_mfma_f32_32x32x16_bf16 v[144:159], v[96:99], v[124:127], v[208:223]
    v_exp_f32 v128, v128
    v_exp_f32 v129, v129
    v_exp_f32 v130, v130
    v_exp_f32 v131, v131
    v_exp_f32 v132, v132
    v_exp_f32 v133, v133
    v_exp_f32 v134, v134
    v_exp_f32 v135, v135
    v_cvt_pk_bf16_f32 v160, v128, v129
    v_cvt_pk_bf16_f32 v161, v130, v131
    v_cvt_pk_bf16_f32 v162, v132, v133
    v_cvt_pk_bf16_f32 v163, v134, v135
    s_nop 1
    v_mfma_f32_32x32x16_bf16 v[192:207], v[40:43], v[160:163], v[192:207]
    v_exp_f32 v136, v136
    v_exp_f32 v137, v137
    v_exp_f32 v138, v138
    v_exp_f32 v139, v139
    v_exp_f32 v140, v140
    v_exp_f32 v141, v141
    v_exp_f32 v142, v142
    v_exp_f32 v143, v143
    v_cvt_pk_bf16_f32 v164, v136, v137
    v_cvt_pk_bf16_f32 v165, v138, v139
    v_cvt_pk_bf16_f32 v166, v140, v141
    v_cvt_pk_bf16_f32 v167, v142, v143
    s_nop 1
    v_mfma_f32_32x32x16_bf16 v[192:207], v[44:47], v[164:167], v[192:207]
    s_cmp_le_u32 s40, 4
    s_cbranch_scc1 L_b_p2done1
    v_mfma_f32_32x32x16_bf16 v[128:143], v[92:95], v[124:127], v[208:223]
    v_exp_f32 v144, v144
    v_exp_f32 v145, v145
    v_exp_f32 v146, v146
    v_exp_f32 v147, v147
    v_exp_f32 v148, v148
    v_exp_f32 v149, v149
    v_exp_f32 v150, v150
    v_exp_f32 v151, v151
    v_cvt_pk_bf16_f32 v160, v144, v145
    v_cvt_pk_bf16_f32 v161, v146, v147
    v_cvt_pk_bf16_f32 v162, v148, v149
    v_cvt_pk_bf16_f32 v163, v150, v151
    s_nop 1
    v_mfma_f32_32x32x16_bf16 v[192:207], v[32:35], v[160:163], v[192:207]
    v_exp_f32 v152, v152
    v_exp_f32 v153, v153
    v_exp_f32 v154, v154
    v_exp_f32 v155, v155
    v_exp_f32 v156, v156
    v_exp_f32 v157, v157
    v_exp_f32 v158, v158
    v_exp_f32 v159, v159
    v_cvt_pk_bf16_f32 v164, v152, v153
    v_cvt_pk_bf16_f32 v165, v154, v155
    v_cvt_pk_bf16_f32 v166, v156, v157
    v_cvt_pk_bf16_f32 v167, v158, v159
    s_nop 1
    v_mfma_f32_32x32x16_bf16 v[192:207], v[36:39], v[164:167], v[192:207]
    s_cmp_le_u32 s40, 5
    s_cbranch_scc1 L_b_p2done1
    v_mfma_f32_32x32x16_bf16 v[144:159], v[88:91], v[124:127], v[208:223]
    v_exp_f32 v128, v128
    v_exp_f32 v129, v129
    v_exp_f32 v130, v130
    v_exp_f32 v131, v131
    v_exp_f32 v132, v132
    v_exp_f32 v133, v133
    v_exp_f32 v134, v134
    v_exp_f32 v135, v135
    v_cvt_pk_bf16_f32 v160, v128, v129
    v_cvt_pk_bf16_f32 v161, v130, v131
    v_cvt_pk_bf16_f32 v162, v132, v133
    v_cvt_pk_bf16_f32 v163, v134, v135
    s_nop 1
    v_mfma_f32_32x32x16_bf16 v[192:207], v[24:27], v[160:163], v[192:207]
    v_exp_f32 v136, v136
    v_exp_f32 v137, v137
    v_exp_f32 v138, v138
    v_exp_f32 v139, v139
    v_exp_f32 v140, v140
    v_exp_f32 v141, v141
    v_exp_f32 v142, v142
    v_exp_f32 v143, v143
    v_cvt_pk_bf16_f32 v164, v136, v137
    v_cvt_pk_bf16_f32 v165, v138, v139
    v_cvt_pk_bf16_f32 v166, v140, v141
    v_cvt_pk_bf16_f32 v167, v142, v143
    s_nop 1
    v_mfma_f32_32x32x16_bf16 v[192:207], v[28:31], v[164:167], v[192:207]
    s_cmp_le_u32 s40, 6
    s_cbranch_scc1 L_b_p2done1
    v_sub_f32 v128, v168, v250
    v_sub_f32 v129, v169, v250
    v_sub_f32 v130, v170, v250
    v_sub_f32 v131, v171, v250
    v_sub_f32 v132, v172, v250
    v_sub_f32 v133, v173, v250
    v_sub_f32 v134, v174, v250
    v_sub_f32 v135, v175, v250
    v_sub_f32 v136, v176, v250
    v_sub_f32 v137, v177, v250
    v_sub_f32 v138, v178, v250
    v_sub_f32 v139, v179, v250
    v_sub_f32 v140, v180, v250
    v_sub_f32 v141, v181, v250
    v_sub_f32 v142, v182, v250
    v_sub_f32 v143, v183, v250
    s_nop 1
    v_mfma_f32_32x32x16_bf16 v[128:143], v[84:87], v[124:127], v[128:143]
    v_exp_f32 v144, v144
    v_exp_f32 v145, v145
    v_exp_f32 v146, v146
    v_exp_f32 v147, v147
    v_exp_f32 v148, v148
    v_exp_f32 v149, v149
    v_exp_f32 v150, v150
    v_exp_f32 v151, v151
    v_cvt_pk_bf16_f32 v160, v144, v145
    v_cvt_pk_bf16_f32 v161, v146, v147
    v_cvt_pk_bf16_f32 v162, v148, v149
    v_cvt_pk_bf16_f32 v163, v150, v151
    s_nop 1
    v_mfma_f32_32x32x16_bf16 v[192:207], v[16:19], v[160:163], v[192:207]
    v_exp_f32 v152, v152
    v_exp_f32 v153, v153
    v_exp_f32 v154, v154
    v_exp_f32 v155, v155
    v_exp_f32 v156, v156
    v_exp_f32 v157, v157
    v_exp_f32 v158, v158
    v_exp_f32 v159, v159
    v_cvt_pk_bf16_f32 v164, v152, v153
    v_cvt_pk_bf16_f32 v165, v154, v155
    v_cvt_pk_bf16_f32 v166, v156, v157
    v_cvt_pk_bf16_f32 v167, v158, v159
    s_nop 1
    v_mfma_f32_32x32x16_bf16 v[192:207], v[20:23], v[164:167], v[192:207]
    s_cmp_le_u32 s40, 7
    s_cbranch_scc1 L_b_p2done1
    v_exp_f32 v128, v128
    v_exp_f32 v129, v129
    v_exp_f32 v130, v130
    v_exp_f32 v131, v131
    v_exp_f32 v132, v132
    v_exp_f32 v133, v133
    v_exp_f32 v134, v134
    v_exp_f32 v135, v135
    v_cvt_pk_bf16_f32 v160, v128, v129
    v_cvt_pk_bf16_f32 v161, v130, v131
    v_cvt_pk_bf16_f32 v162, v132, v133
    v_cvt_pk_bf16_f32 v163, v134, v135
    s_nop 1
    v_mfma_f32_32x32x16_bf16 v[192:207], v[8:11], v[160:163], v[192:207]
    v_exp_f32 v136, v136
    v_exp_f32 v137, v137
    v_exp_f32 v138, v138
    v_exp_f32 v139, v139
    v_exp_f32 v140, v140
    v_exp_f32 v141, v141
    v_exp_f32 v142, v142
    v_exp_f32 v143, v143
    v_cvt_pk_bf16_f32 v164, v136, v137
    v_cvt_pk_bf16_f32 v165, v138, v139
    v_cvt_pk_bf16_f32 v166, v140, v141
    v_cvt_pk_bf16_f32 v167, v142, v143
    s_nop 1
    v_mfma_f32_32x32x16_bf16 v[192:207], v[12:15], v[164:167], v[192:207]
L_b_p2done1:
    s_nop 11
    v_rcp_f32 v252, v200
    s_nop 0
    v_mul_f32 v192, v252, v192
    v_mul_f32 v193, v252, v193
    v_mul_f32 v194, v252, v194
    v_mul_f32 v195, v252, v195
    v_mul_f32 v196, v252, v196
    v_mul_f32 v197, v252, v197
    v_mul_f32 v198, v252, v198
    v_mul_f32 v199, v252, v199
    v_cvt_pk_bf16_f32 v144, v192, v193
    v_cvt_pk_bf16_f32 v145, v194, v195
    v_cvt_pk_bf16_f32 v146, v196, v197
    v_cvt_pk_bf16_f32 v147, v198, v199
    buffer_store_dwordx4 v[144:147], v184, s[16:19], s33 offen
    s_branch L_b_att_done
.section .rodata,"a"
.p2align 6
.amdhsa_kernel concat_heads__ssm_conv_h3__sliding_block__prompt_kernel
  .amdhsa_next_free_vgpr 256
  .amdhsa_next_free_sgpr 102
  .amdhsa_accum_offset 256
  .amdhsa_group_segment_fixed_size 0
  .amdhsa_kernarg_size 96
  .amdhsa_user_sgpr_count 2
  .amdhsa_user_sgpr_kernarg_segment_ptr 1
  .amdhsa_system_sgpr_workgroup_id_x 1
.end_amdhsa_kernel
```
